```python
import torch

def _softmax(x, axis=-1):
    return torch.softmax(x, dim=axis)
def _gelu(x):
    return torch.nn.functional.gelu(x, approximate="tanh")
def _silu(x):
    return torch.nn.functional.silu(x)
def _sigmoid(x):
    return torch.sigmoid(x)
def _layernorm(x, axis=-1, eps=1e-5):
    m = x.mean(dim=axis, keepdim=True)
    v = x.var(dim=axis, keepdim=True, unbiased=False)
    return (x - m) / torch.sqrt(v + eps)
def _scatter_add(tgt, idx, src, axis=0):
    return tgt.clone().index_add_(axis, idx, src)
def _segment_sum(src, seg, n):
    out = torch.zeros((n,) + src.shape[1:], dtype=src.dtype)
    return out.index_add_(0, seg, src)
def _pad(x, pw):
    flat = tuple(v for pair in reversed(pw) for v in pair)
    return torch.nn.functional.pad(x, flat)

kernel_name = 'parallel_sum__gqa_block_cached__dense_activation_squared_relu__decode'

def setup_inputs():

    _w = (lambda a: (lambda t: t.to(torch.bfloat16) if t.is_floating_point() else t)(torch.as_tensor(a)))
    def _A_setup():
        B, Sq, D = 4, 1, 640
        Hq, Hkv, Sk, Dh = 32, 32, 8192, 192
        assert Hq % Hkv == 0, (Hq, Hkv)
        return {
            "x": _w((lambda *s: torch.randn(*s, dtype=torch.bfloat16) * 0.05)(B, Sq, D)),
            "k_cache": _w((lambda *s: torch.randn(*s, dtype=torch.bfloat16) * 1.6)(B, Hkv, Sk, Dh)),
            "v_cache": _w((lambda *s: torch.randn(*s, dtype=torch.bfloat16) * 3.2)(B, Hkv, Sk, Dh)),
            "wq": _w((lambda *s: torch.randn(*s, dtype=torch.bfloat16) * 1.6)(D, Hq * Dh) * (D ** -0.5)),
            "wo": _w((lambda *s: torch.randn(*s, dtype=torch.bfloat16) * 3.2)(Hq * Dh, D) * ((Hq * Dh) ** -0.5)),
        }
    _A_in = _A_setup()

    def _B_setup():
        B, S, D, F = 4, 1, 640, 1536
        return {
            "x": _w((lambda *s: torch.randn(*s, dtype=torch.bfloat16) * 0.05)(B, S, D)),
            "w1": _w((lambda *s: torch.randn(*s, dtype=torch.bfloat16) * 0.05)(D, F)),
            "b1": _w((lambda *s: torch.randn(*s, dtype=torch.bfloat16) * 0.2)(F)),
            "w2": _w((lambda *s: torch.randn(*s, dtype=torch.bfloat16) * 0.05)(F, D)),
            "b2": _w((lambda *s: torch.randn(*s, dtype=torch.bfloat16) * 0.8)(D)),
        }
    _B_in = _B_setup()

    return {
        "A_x": _A_in["x"],
        "A_k_cache": _A_in["k_cache"],
        "A_v_cache": _A_in["v_cache"],
        "A_wq": _A_in["wq"],
        "A_wo": _A_in["wo"],
        "B_x": _B_in["x"],
        "B_w1": _B_in["w1"],
        "B_b1": _B_in["b1"],
        "B_w2": _B_in["w2"],
        "B_b2": _B_in["b2"],
    }

def reference(A_x, A_k_cache, A_v_cache, A_wq, A_wo, B_x, B_w1, B_b1, B_w2, B_b2):
    def _A_ref(x, k_cache, v_cache, wq, wo):
        B, Sq, D = x.shape
        Hq, Dh = 32, 192
        Hkv = k_cache.shape[1]
        rep = Hq // Hkv
        q = (lambda x, *d: x.permute(*d))((x @ wq).reshape(B, Sq, Hq, Dh), 0, 2, 1, 3)
        k = (lambda x, n, axis: torch.repeat_interleave(x, n, dim=axis))(k_cache, rep, axis=1)
        v = (lambda x, n, axis: torch.repeat_interleave(x, n, dim=axis))(v_cache, rep, axis=1)
        scores = torch.einsum("bhqd,bhkd->bhqk", q, k) * (Dh ** -0.5)
        p = _softmax(scores, axis=-1)
        o = torch.einsum("bhqk,bhkd->bhqd", p, v)
        return (lambda x, *d: x.permute(*d))(o, 0, 2, 1, 3).reshape(B, Sq, Hq * Dh) @ wo

    def _B_ref(x, w1, b1, w2, b2):
        h = torch.einsum("bsd,df->bsf", x, w1) + b1
        zero = torch.zeros_like(h)
        r = torch.where(h > zero, h, zero)
        h = r * r
        out = torch.einsum("bsf,fd->bsd", h, w2) + b2
        return out

    x = A_x
    xn = _layernorm(x, axis=-1)
    return x + _A_ref(xn, A_k_cache, A_v_cache, A_wq, A_wo) + _B_ref(xn, B_w1, B_b1, B_w2, B_b2)
```

```asm
; @launch kernel=parallel_sum__gqa_block_cached__dense_activation_squared_relu__decode_kernel grid=(256,1,1) block=(1024,1,1) lds=151808
; @launch kernel=final_kernel grid=(160,1,1) block=(256,1,1) lds=512
.amdgcn_target "amdgcn-amd-amdhsa--gfx950"
.text
.globl parallel_sum__gqa_block_cached__dense_activation_squared_relu__decode_kernel
.p2align 12
.p2align 8
.type parallel_sum__gqa_block_cached__dense_activation_squared_relu__decode_kernel,@function
parallel_sum__gqa_block_cached__dense_activation_squared_relu__decode_kernel:
s_cmp_ge_u32 s2, 256
s_cbranch_scc1 L_end
s_load_dwordx16 s[64:79], s[0:1], 0
s_load_dwordx8 s[80:87], s[0:1], 64
s_load_dwordx2 s[88:89], s[0:1], 96
v_lshrrev_b32 v1, 6, v0
v_and_b32 v0, 63, v0
s_and_b32 s16, s2, 7
v_readfirstlane_b32 s3, v1
s_lshr_b32 s17, s2, 3
s_and_b32 s58, s17, 7
s_lshr_b32 s17, s17, 3
s_lshl_b32 s5, s16, 2
s_add_u32 s5, s5, s17
s_cmp_eq_u32 s3, 0
s_cbranch_scc1 L_loader
v_and_b32 v4, 31, v0
v_lshlrev_b32 v4, 2, v4
v_add_u32 v4, 151552, v4
v_mov_b32 v5, 0
s_setprio 2
ds_write_b32 v4, v5
s_cmp_lt_u32 s3, 5
s_cbranch_scc1 L_cons
s_cmp_eq_u32 s3, 5
s_cbranch_scc1 L_mgr
s_sub_u32 s18, s3, 6
s_cmp_ge_u32 s58, 3
s_cselect_b32 s6, 1, 0
s_mul_i32 s16, s6, 3
s_sub_u32 s22, s58, s16
s_mul_i32 s16, s5, 384
s_lshl_b32 s17, s22, 7
s_add_u32 s16, s16, s17
s_mul_i32 s17, s5, 96
s_and_b32 s19, s58, 1
s_movk_i32 s23, 0x3000
s_cmp_lt_u32 s58, 6
s_cselect_b32 s16, s16, s17
s_cselect_b32 s23, s23, 3072
s_cselect_b32 s6, s6, s19
v_and_b32 v2, 15, v0
v_lshrrev_b32 v3, 4, v0
s_lshl_b32 s17, s23, 3
v_mul_lo_u32 v4, v3, s17
v_lshl_add_u32 v4, v2, 3, v4
s_mul_i32 s10, s23, 640
s_sub_u32 s10, s10, s16
s_mov_b32 s11, 0x20000
s_mul_i32 s19, s6, 10
s_add_u32 s19, s19, s18
s_mul_i32 s20, s19, s23
s_lshl_b32 s20, s20, 5
s_cmp_lt_u32 s58, 6
s_waitcnt lgkmcnt(0)
s_cselect_b64 s[8:9], s[70:71], s[76:77]
s_add_u32 s8, s8, s16
s_addc_u32 s9, s9, 0
s_barrier
s_cmp_lt_u32 s58, 6
s_cbranch_scc1 L_w1n
v_cmp_lt_u32 vcc, 11, v2
v_mov_b32 v5, 0x7fff0000
s_nop 0
v_cndmask_b32 v4, v4, v5, vcc
L_w1n:
buffer_load_dwordx2 v[16:17], v4, s[8:11], s20 offen nt
s_add_u32 s20, s20, s23
buffer_load_dwordx2 v[18:19], v4, s[8:11], s20 offen nt
s_add_u32 s20, s20, s23
buffer_load_dwordx2 v[20:21], v4, s[8:11], s20 offen nt
s_add_u32 s20, s20, s23
buffer_load_dwordx2 v[22:23], v4, s[8:11], s20 offen nt
s_add_u32 s20, s20, s23
buffer_load_dwordx2 v[24:25], v4, s[8:11], s20 offen nt
s_add_u32 s20, s20, s23
buffer_load_dwordx2 v[26:27], v4, s[8:11], s20 offen nt
s_add_u32 s20, s20, s23
buffer_load_dwordx2 v[28:29], v4, s[8:11], s20 offen nt
s_add_u32 s20, s20, s23
buffer_load_dwordx2 v[30:31], v4, s[8:11], s20 offen nt
s_mov_b32 s44, 0x05040100
s_mov_b32 s45, 0x07060302
v_and_b32 v5, 3, v2
v_lshrrev_b32 v6, 2, v2
v_mul_u32_u24 v7, 1280, v5
v_lshl_add_u32 v7, v3, 4, v7
s_lshl_b32 s16, s19, 6
s_add_u32 s16, s16, 122880
v_add_u32 v7, s16, v7
v_cmp_eq_u32 s[30:31], 0, v6
v_cmp_eq_u32 s[32:33], 1, v6
v_cmp_eq_u32 s[34:35], 2, v6
v_cmp_eq_u32 s[36:37], 3, v6
s_lshl_b32 s16, s18, 10
s_add_u32 s16, s16, 139264
v_lshlrev_b32 v5, 4, v0
v_add_u32 v5, s16, v5
v_mov_b32 v13, 151584
L_pollx:
ds_read_b32 v14, v13
s_waitcnt lgkmcnt(0)
v_readfirstlane_b32 s24, v14
s_nop 0
s_cmp_ge_u32 s24, 4
s_cbranch_scc1 L_pollokx
s_sleep 1
s_branch L_pollx
L_pollokx:
ds_read_b128 v[112:115], v7
s_waitcnt lgkmcnt(0)
v_cndmask_b32 v48, 0, v112, s[30:31]
v_cndmask_b32 v49, 0, v113, s[30:31]
v_cndmask_b32 v50, 0, v114, s[30:31]
v_cndmask_b32 v51, 0, v115, s[30:31]
v_cndmask_b32 v52, 0, v112, s[32:33]
v_cndmask_b32 v53, 0, v113, s[32:33]
v_cndmask_b32 v54, 0, v114, s[32:33]
v_cndmask_b32 v55, 0, v115, s[32:33]
v_cndmask_b32 v56, 0, v112, s[34:35]
v_cndmask_b32 v57, 0, v113, s[34:35]
v_cndmask_b32 v58, 0, v114, s[34:35]
v_cndmask_b32 v59, 0, v115, s[34:35]
v_cndmask_b32 v60, 0, v112, s[36:37]
v_cndmask_b32 v61, 0, v113, s[36:37]
v_cndmask_b32 v62, 0, v114, s[36:37]
v_cndmask_b32 v63, 0, v115, s[36:37]
s_waitcnt vmcnt(0)
v_perm_b32 v64, v18, v16, s44
v_perm_b32 v65, v22, v20, s44
v_perm_b32 v66, v26, v24, s44
v_perm_b32 v67, v30, v28, s44
v_perm_b32 v68, v18, v16, s45
v_perm_b32 v69, v22, v20, s45
v_perm_b32 v70, v26, v24, s45
v_perm_b32 v71, v30, v28, s45
v_mfma_f32_16x16x32_bf16 v[80:83], v[64:67], v[48:51], 0
v_perm_b32 v72, v19, v17, s44
v_perm_b32 v73, v23, v21, s44
v_perm_b32 v74, v27, v25, s44
v_perm_b32 v75, v31, v29, s44
v_mfma_f32_16x16x32_bf16 v[80:83], v[68:71], v[52:55], v[80:83]
v_perm_b32 v76, v19, v17, s45
v_perm_b32 v77, v23, v21, s45
v_perm_b32 v78, v27, v25, s45
v_perm_b32 v79, v31, v29, s45
v_mfma_f32_16x16x32_bf16 v[80:83], v[72:75], v[56:59], v[80:83]
s_nop 0
v_mfma_f32_16x16x32_bf16 v[80:83], v[76:79], v[60:63], v[80:83]
v_mov_b32 v13, 151588
v_mov_b32 v14, 1
s_nop 5
ds_write_b128 v5, v[80:83]
s_mov_b64 exec, 1
s_waitcnt lgkmcnt(0)
ds_add_u32 v13, v14
ds_add_u32 v13, v14 offset:20
s_mov_b64 exec, -1
s_setprio 0
s_branch L_prest
L_cons:
s_sub_u32 s18, s3, 1
v_lshlrev_b32 v7, 2, v0
s_mul_i32 s16, s18, 1280
s_movk_i32 s10, 1280
s_mov_b32 s11, 0x20000
s_waitcnt lgkmcnt(0)
s_add_u32 s8, s64, s16
s_addc_u32 s9, s65, 0
buffer_load_dword v48, v7, s[8:11], 0 offen offset:0 nt
buffer_load_dword v49, v7, s[8:11], 0 offen offset:256 nt
buffer_load_dword v50, v7, s[8:11], 0 offen offset:512 nt
buffer_load_dword v51, v7, s[8:11], 0 offen offset:768 nt
buffer_load_dword v52, v7, s[8:11], 0 offen offset:1024 nt
s_barrier
s_add_u32 s16, s16, 122880
v_add_u32 v11, s16, v7
s_mov_b32 s36, 0x3f803f80
v_mov_b32 v96, 0
s_waitcnt vmcnt(0)
v_dot2c_f32_bf16 v96, s36, v48
v_dot2c_f32_bf16 v96, s36, v49
v_dot2c_f32_bf16 v96, s36, v50
v_dot2c_f32_bf16 v96, s36, v51
v_dot2c_f32_bf16 v96, s36, v52
v_lshlrev_b32 v60, 16, v48
v_and_b32 v61, 0xffff0000, v48
v_lshlrev_b32 v62, 16, v49
v_and_b32 v63, 0xffff0000, v49
v_lshlrev_b32 v64, 16, v50
v_and_b32 v65, 0xffff0000, v50
v_lshlrev_b32 v66, 16, v51
v_and_b32 v67, 0xffff0000, v51
v_lshlrev_b32 v68, 16, v52
v_and_b32 v69, 0xffff0000, v52
s_nop 1
v_add_f32_dpp v96, v96, v96 quad_perm:[1,0,3,2] row_mask:0xf bank_mask:0xf
s_nop 1
v_add_f32_dpp v96, v96, v96 quad_perm:[2,3,0,1] row_mask:0xf bank_mask:0xf
s_nop 1
v_add_f32_dpp v96, v96, v96 row_half_mirror row_mask:0xf bank_mask:0xf
s_nop 1
v_add_f32_dpp v96, v96, v96 row_mirror row_mask:0xf bank_mask:0xf
v_mov_b32 v97, v96
s_nop 1
v_permlane16_swap_b32 v96, v97
s_nop 0
v_add_f32 v96, v96, v97
v_mov_b32 v97, v96
s_nop 1
v_permlane32_swap_b32 v96, v97
s_nop 0
v_add_f32 v96, v96, v97
v_mul_f32 v96, 986500301, v96
v_sub_f32 v70, v60, v96
v_sub_f32 v71, v61, v96
v_sub_f32 v72, v62, v96
v_sub_f32 v73, v63, v96
v_sub_f32 v74, v64, v96
v_sub_f32 v75, v65, v96
v_sub_f32 v76, v66, v96
v_sub_f32 v77, v67, v96
v_sub_f32 v78, v68, v96
v_sub_f32 v79, v69, v96
v_mul_f32 v98, v70, v70
v_mul_f32 v99, v71, v71
v_fmac_f32 v98, v72, v72
v_fmac_f32 v99, v73, v73
v_fmac_f32 v98, v74, v74
v_fmac_f32 v99, v75, v75
v_fmac_f32 v98, v76, v76
v_fmac_f32 v99, v77, v77
v_fmac_f32 v98, v78, v78
v_fmac_f32 v99, v79, v79
v_add_f32 v98, v98, v99
v_cvt_pk_bf16_f32 v96, v96, v96
v_and_b32 v96, 0xffff0000, v96
v_sub_f32 v60, v60, v96
v_sub_f32 v61, v61, v96
v_sub_f32 v62, v62, v96
v_sub_f32 v63, v63, v96
v_sub_f32 v64, v64, v96
v_sub_f32 v65, v65, v96
v_sub_f32 v66, v66, v96
v_sub_f32 v67, v67, v96
v_sub_f32 v68, v68, v96
v_sub_f32 v69, v69, v96
s_nop 1
v_add_f32_dpp v98, v98, v98 quad_perm:[1,0,3,2] row_mask:0xf bank_mask:0xf
s_nop 1
v_add_f32_dpp v98, v98, v98 quad_perm:[2,3,0,1] row_mask:0xf bank_mask:0xf
s_nop 1
v_add_f32_dpp v98, v98, v98 row_half_mirror row_mask:0xf bank_mask:0xf
s_nop 1
v_add_f32_dpp v98, v98, v98 row_mirror row_mask:0xf bank_mask:0xf
v_mov_b32 v97, v98
s_nop 1
v_permlane16_swap_b32 v98, v97
s_nop 0
v_add_f32 v98, v98, v97
v_mov_b32 v97, v98
s_nop 1
v_permlane32_swap_b32 v98, v97
s_nop 0
v_add_f32 v98, v98, v97
v_mul_f32 v98, 986500301, v98
v_cvt_pk_bf16_f32 v98, v98, v98
v_and_b32 v98, 0xffff0000, v98
v_add_f32 v98, 925353388, v98
v_cvt_pk_bf16_f32 v98, v98, v98
v_and_b32 v98, 0xffff0000, v98
v_sqrt_f32 v98, v98
v_cvt_pk_bf16_f32 v48, v60, v61
v_cvt_pk_bf16_f32 v49, v62, v63
v_cvt_pk_bf16_f32 v50, v64, v65
v_cvt_pk_bf16_f32 v51, v66, v67
v_cvt_pk_bf16_f32 v52, v68, v69
v_cvt_pk_bf16_f32 v98, v98, v98
v_and_b32 v98, 0xffff0000, v98
v_rcp_f32 v99, v98
v_lshlrev_b32 v60, 16, v48
v_and_b32 v61, 0xffff0000, v48
v_lshlrev_b32 v62, 16, v49
v_and_b32 v63, 0xffff0000, v49
v_lshlrev_b32 v64, 16, v50
v_and_b32 v65, 0xffff0000, v50
v_lshlrev_b32 v66, 16, v51
v_and_b32 v67, 0xffff0000, v51
v_lshlrev_b32 v68, 16, v52
v_and_b32 v69, 0xffff0000, v52
v_mul_f32 v70, v60, v99
v_mul_f32 v71, v61, v99
v_mul_f32 v72, v62, v99
v_mul_f32 v73, v63, v99
v_mul_f32 v74, v64, v99
v_mul_f32 v75, v65, v99
v_mul_f32 v76, v66, v99
v_mul_f32 v77, v67, v99
v_mul_f32 v78, v68, v99
v_mul_f32 v79, v69, v99
v_fma_f32 v60, -v70, v98, v60
v_fma_f32 v61, -v71, v98, v61
v_fma_f32 v62, -v72, v98, v62
v_fma_f32 v63, -v73, v98, v63
v_fma_f32 v64, -v74, v98, v64
v_fma_f32 v65, -v75, v98, v65
v_fma_f32 v66, -v76, v98, v66
v_fma_f32 v67, -v77, v98, v67
v_fma_f32 v68, -v78, v98, v68
v_fma_f32 v69, -v79, v98, v69
v_fmac_f32 v70, v60, v99
v_fmac_f32 v71, v61, v99
v_fmac_f32 v72, v62, v99
v_fmac_f32 v73, v63, v99
v_fmac_f32 v74, v64, v99
v_fmac_f32 v75, v65, v99
v_fmac_f32 v76, v66, v99
v_fmac_f32 v77, v67, v99
v_fmac_f32 v78, v68, v99
v_fmac_f32 v79, v69, v99
v_cvt_pk_bf16_f32 v48, v70, v71
ds_write_b32 v11, v48 offset:0
v_cvt_pk_bf16_f32 v49, v72, v73
ds_write_b32 v11, v49 offset:256
v_cvt_pk_bf16_f32 v50, v74, v75
ds_write_b32 v11, v50 offset:512
v_cvt_pk_bf16_f32 v51, v76, v77
ds_write_b32 v11, v51 offset:768
v_cvt_pk_bf16_f32 v52, v78, v79
ds_write_b32 v11, v52 offset:1024
s_waitcnt lgkmcnt(0)
v_mov_b32 v96, 151584
v_mov_b32 v97, 1
s_mov_b64 exec, 1
ds_add_u32 v96, v97
s_mov_b64 exec, -1
s_branch L_crest
L_loader:
s_setprio 3
s_mul_i32 s19, s5, 3145728
v_lshlrev_b32 v2, 4, v0
s_mul_i32 s20, s58, 24576
s_mul_i32 s17, s5, 13
s_and_b32 s17, s17, 15
s_mul_i32 s17, s17, 196608
s_add_u32 s20, s20, s17
s_mov_b32 s21, 0
s_mov_b32 s22, 0
s_mov_b32 s10, 402653184
s_mov_b32 s11, 0x20000
v_mov_b32 v4, 151552
v_mov_b32 v12, 151608
s_mov_b32 s46, 0
s_mov_b32 s27, 0
s_waitcnt lgkmcnt(0)
s_mov_b64 s[8:9], s[66:67]
s_mov_b32 m0, s21
s_add_u32 s23, s20, s19
buffer_load_dwordx4 v2, s[8:11], s23 offen offset:0 nt lds
buffer_load_dwordx4 v2, s[8:11], s23 offen offset:1024 nt lds
buffer_load_dwordx4 v2, s[8:11], s23 offen offset:2048 nt lds
buffer_load_dwordx4 v2, s[8:11], s23 offen offset:3072 nt lds
s_add_u32 m0, s21, 4096
s_add_u32 s23, s23, 4096
buffer_load_dwordx4 v2, s[8:11], s23 offen offset:0 nt lds
buffer_load_dwordx4 v2, s[8:11], s23 offen offset:1024 nt lds
buffer_load_dwordx4 v2, s[8:11], s23 offen offset:2048 nt lds
buffer_load_dwordx4 v2, s[8:11], s23 offen offset:3072 nt lds
s_add_u32 m0, s21, 8192
s_add_u32 s23, s23, 4096
buffer_load_dwordx4 v2, s[8:11], s23 offen offset:0 nt lds
buffer_load_dwordx4 v2, s[8:11], s23 offen offset:1024 nt lds
buffer_load_dwordx4 v2, s[8:11], s23 offen offset:2048 nt lds
buffer_load_dwordx4 v2, s[8:11], s23 offen offset:3072 nt lds
s_barrier
ds_read_b32 v13, v12
s_branch L_mN
L_ld:
s_cmp_ge_u32 s27, 20
s_cbranch_scc1 L_mC
s_waitcnt lgkmcnt(0)
v_readfirstlane_b32 s27, v13
ds_read_b32 v13, v12
s_cmp_ge_u32 s27, 10
s_cbranch_scc1 L_mB
s_sub_i32 s25, s22, 10
s_ashr_i32 s25, s25, 2
s_add_i32 s25, s25, 1
L_chka:
s_waitcnt lgkmcnt(0)
v_readfirstlane_b32 s24, v11
s_nop 0
s_cmp_ge_i32 s24, s25
s_cbranch_scc1 L_oka
s_waitcnt vmcnt(0)
v_mov_b32 v5, s22
ds_write_b32 v4, v5
s_sleep 1
ds_read_b32 v11, v10
s_branch L_chka
L_oka:
s_mov_b32 m0, s21
s_add_u32 s23, s20, s19
s_waitcnt vmcnt(12)
s_sub_i32 s26, s22, 1
s_max_i32 s26, s26, 0
v_mov_b32 v5, s26
ds_max_u32 v4, v5
buffer_load_dwordx4 v2, s[8:11], s23 offen offset:0 nt lds
buffer_load_dwordx4 v2, s[8:11], s23 offen offset:1024 nt lds
buffer_load_dwordx4 v2, s[8:11], s23 offen offset:2048 nt lds
buffer_load_dwordx4 v2, s[8:11], s23 offen offset:3072 nt lds
s_add_u32 m0, s21, 4096
s_add_u32 s23, s23, 4096
buffer_load_dwordx4 v2, s[8:11], s23 offen offset:0 nt lds
buffer_load_dwordx4 v2, s[8:11], s23 offen offset:1024 nt lds
s_waitcnt vmcnt(12)
buffer_load_dwordx4 v2, s[8:11], s23 offen offset:2048 nt lds
buffer_load_dwordx4 v2, s[8:11], s23 offen offset:3072 nt lds
s_add_u32 m0, s21, 8192
s_add_u32 s23, s23, 4096
buffer_load_dwordx4 v2, s[8:11], s23 offen offset:0 nt lds
buffer_load_dwordx4 v2, s[8:11], s23 offen offset:1024 nt lds
buffer_load_dwordx4 v2, s[8:11], s23 offen offset:2048 nt lds
buffer_load_dwordx4 v2, s[8:11], s23 offen offset:3072 nt lds
s_branch L_mN
L_mB:
s_sub_u32 s26, s22, 16
s_cmp_lt_u32 s26, 10
s_cbranch_scc1 L_mC
s_sub_i32 s25, s22, 10
s_ashr_i32 s25, s25, 2
s_add_i32 s25, s25, 1
L_chkb:
s_waitcnt lgkmcnt(0)
v_readfirstlane_b32 s24, v11
s_nop 0
s_cmp_ge_i32 s24, s25
s_cbranch_scc1 L_okb
s_waitcnt vmcnt(0)
v_mov_b32 v5, s22
ds_write_b32 v4, v5
s_sleep 1
ds_read_b32 v11, v10
s_branch L_chkb
L_okb:
s_mov_b32 m0, s21
s_add_u32 s23, s20, s19
s_waitcnt vmcnt(24)
s_sub_i32 s26, s22, 2
s_max_i32 s26, s26, 0
v_mov_b32 v5, s26
ds_max_u32 v4, v5
buffer_load_dwordx4 v2, s[8:11], s23 offen offset:0 nt lds
buffer_load_dwordx4 v2, s[8:11], s23 offen offset:1024 nt lds
buffer_load_dwordx4 v2, s[8:11], s23 offen offset:2048 nt lds
buffer_load_dwordx4 v2, s[8:11], s23 offen offset:3072 nt lds
s_add_u32 m0, s21, 4096
s_add_u32 s23, s23, 4096
buffer_load_dwordx4 v2, s[8:11], s23 offen offset:0 nt lds
buffer_load_dwordx4 v2, s[8:11], s23 offen offset:1024 nt lds
buffer_load_dwordx4 v2, s[8:11], s23 offen offset:2048 nt lds
buffer_load_dwordx4 v2, s[8:11], s23 offen offset:3072 nt lds
s_add_u32 m0, s21, 8192
s_add_u32 s23, s23, 4096
buffer_load_dwordx4 v2, s[8:11], s23 offen offset:0 nt lds
buffer_load_dwordx4 v2, s[8:11], s23 offen offset:1024 nt lds
buffer_load_dwordx4 v2, s[8:11], s23 offen offset:2048 nt lds
buffer_load_dwordx4 v2, s[8:11], s23 offen offset:3072 nt lds
s_branch L_mN
L_mC:
s_cmp_lt_u32 s22, 232
s_cbranch_scc1 L_mC1
s_sub_i32 s25, s22, 10
s_ashr_i32 s25, s25, 2
s_add_i32 s25, s25, 1
L_chke0:
s_waitcnt lgkmcnt(0)
v_readfirstlane_b32 s24, v11
s_nop 0
s_cmp_ge_i32 s24, s25
s_cbranch_scc1 L_oke0
s_waitcnt vmcnt(0)
v_mov_b32 v5, s22
ds_write_b32 v4, v5
s_sleep 1
ds_read_b32 v11, v10
s_branch L_chke0
L_oke0:
s_mov_b32 m0, s21
s_add_u32 s23, s20, s19
s_waitcnt vmcnt(48)
s_sub_i32 s26, s22, 4
s_max_i32 s26, s26, 0
v_mov_b32 v5, s26
ds_max_u32 v4, v5
buffer_load_dwordx4 v2, s[8:11], s23 offen offset:0 nt lds
buffer_load_dwordx4 v2, s[8:11], s23 offen offset:1024 nt lds
buffer_load_dwordx4 v2, s[8:11], s23 offen offset:2048 nt lds
buffer_load_dwordx4 v2, s[8:11], s23 offen offset:3072 nt lds
s_add_u32 m0, s21, 4096
s_add_u32 s23, s23, 4096
buffer_load_dwordx4 v2, s[8:11], s23 offen offset:0 nt lds
buffer_load_dwordx4 v2, s[8:11], s23 offen offset:1024 nt lds
buffer_load_dwordx4 v2, s[8:11], s23 offen offset:2048 nt lds
buffer_load_dwordx4 v2, s[8:11], s23 offen offset:3072 nt lds
s_add_u32 m0, s21, 8192
s_add_u32 s23, s23, 4096
buffer_load_dwordx4 v2, s[8:11], s23 offen offset:0 nt lds
buffer_load_dwordx4 v2, s[8:11], s23 offen offset:1024 nt lds
buffer_load_dwordx4 v2, s[8:11], s23 offen offset:2048 nt lds
buffer_load_dwordx4 v2, s[8:11], s23 offen offset:3072 nt lds
s_branch L_mN
L_mC1:
s_sub_i32 s25, s22, 10
s_ashr_i32 s25, s25, 2
s_add_i32 s25, s25, 1
L_chkk:
s_waitcnt lgkmcnt(0)
v_readfirstlane_b32 s24, v11
s_nop 0
s_cmp_ge_i32 s24, s25
s_cbranch_scc1 L_okk
s_waitcnt vmcnt(0)
v_mov_b32 v5, s22
ds_write_b32 v4, v5
s_sleep 1
ds_read_b32 v11, v10
s_branch L_chkk
L_okk:
s_mov_b32 m0, s21
s_add_u32 s23, s20, s19
s_waitcnt vmcnt(12)
s_sub_i32 s26, s22, 1
s_max_i32 s26, s26, 0
v_mov_b32 v5, s26
ds_max_u32 v4, v5
buffer_load_dwordx4 v2, s[8:11], s23 offen offset:0 nt lds
buffer_load_dwordx4 v2, s[8:11], s23 offen offset:1024 nt lds
buffer_load_dwordx4 v2, s[8:11], s23 offen offset:2048 nt lds
buffer_load_dwordx4 v2, s[8:11], s23 offen offset:3072 nt lds
s_add_u32 m0, s21, 4096
s_add_u32 s23, s23, 4096
buffer_load_dwordx4 v2, s[8:11], s23 offen offset:0 nt lds
buffer_load_dwordx4 v2, s[8:11], s23 offen offset:1024 nt lds
buffer_load_dwordx4 v2, s[8:11], s23 offen offset:2048 nt lds
buffer_load_dwordx4 v2, s[8:11], s23 offen offset:3072 nt lds
s_add_u32 m0, s21, 8192
s_add_u32 s23, s23, 4096
buffer_load_dwordx4 v2, s[8:11], s23 offen offset:0 nt lds
buffer_load_dwordx4 v2, s[8:11], s23 offen offset:1024 nt lds
buffer_load_dwordx4 v2, s[8:11], s23 offen offset:2048 nt lds
buffer_load_dwordx4 v2, s[8:11], s23 offen offset:3072 nt lds
L_mN:
s_add_u32 s22, s22, 1
s_and_b32 s26, s22, 1
s_mov_b32 s26, 184320
s_cselect_b32 s26, 12288, s26
s_add_u32 s20, s20, s26
s_cmp_ge_u32 s20, 3145728
s_cselect_b32 s26, 3145728, 0
s_sub_u32 s20, s20, s26
s_add_u32 s21, s21, 12288
s_cmp_ge_u32 s21, 122880
s_cselect_b32 s21, 0, s21
s_sub_u32 s26, s22, 10
s_and_b32 s26, s26, 3
s_lshl_b32 s26, s26, 2
s_add_u32 s26, s26, 151568
v_mov_b32 v10, s26
ds_read_b32 v11, v10
s_and_b32 s26, s22, 31
s_cbranch_scc1 L_ld
s_add_u32 s19, s19, 100663296
s_cmp_lg_u32 s22, 128
s_cbranch_scc1 L_nsw
s_mov_b64 s[8:9], s[68:69]
s_sub_u32 s19, s19, 402653184
L_nsw:
s_cmp_lt_u32 s22, 256
s_cbranch_scc1 L_ld
s_waitcnt vmcnt(48)
v_mov_b32 v5, 252
ds_max_u32 v4, v5
s_waitcnt vmcnt(36)
v_mov_b32 v5, 253
ds_max_u32 v4, v5
s_waitcnt vmcnt(24)
v_mov_b32 v5, 254
ds_max_u32 v4, v5
s_waitcnt vmcnt(12)
v_mov_b32 v5, 255
ds_max_u32 v4, v5
s_waitcnt vmcnt(0)
v_mov_b32 v5, 256
ds_max_u32 v4, v5
s_waitcnt lgkmcnt(0)
s_endpgm
L_mgr:
s_lshl_b32 s16, s5, 8
s_add_u32 s16, s16, 524288
s_movk_i32 s10, 8
s_mov_b32 s11, 0x20000
v_mov_b32 v9, 0
s_waitcnt lgkmcnt(0)
s_add_u32 s8, s88, s16
s_addc_u32 s9, s89, 0
buffer_load_dwordx2 v[10:11], v9, s[8:11], 0 offen sc1
s_barrier
s_lshl_b32 s16, s5, 14
s_add_u32 s12, s88, s16
s_addc_u32 s13, s89, 0
s_movk_i32 s14, 16384
s_mov_b32 s15, 0x20000
s_mul_i32 s16, s5, 96
s_add_u32 s36, s78, s16
s_addc_u32 s37, s79, 0
s_movk_i32 s38, 96
s_mov_b32 s39, 0x20000
v_bfe_u32 v2, v0, 3, 2
v_bfe_u32 v3, v0, 1, 2
v_and_b32 v4, 1, v0
v_lshlrev_b32 v2, 5, v2
v_lshl_add_u32 v2, v4, 4, v2
v_lshl_add_u32 v2, v3, 1, v2
buffer_load_ushort v20, v2, s[36:39], 0 offen nt
buffer_load_ushort v21, v2, s[36:39], 0 offen offset:8 nt
v_lshrrev_b32 v3, 5, v0
v_lshl_add_u32 v7, v3, 7, v2
v_add_u32 v7, 149504, v7
v_lshlrev_b32 v8, 4, v0
v_add_u32 v6, 139264, v8
v_and_b32 v2, 3, v0
v_lshrrev_b32 v3, 2, v0
v_lshlrev_b32 v14, 12, v2
v_lshl_add_u32 v14, v3, 5, v14
s_cmp_ge_u32 s58, 3
s_cselect_b32 s6, 1, 0
s_mul_i32 s16, s6, 3
s_sub_u32 s22, s58, s16
s_and_b32 s19, s58, 1
s_cmp_lt_u32 s58, 6
s_cselect_b32 s6, s6, s19
s_cselect_b32 s22, s22, 3
s_lshl_b32 s19, s6, 11
s_lshl_b32 s16, s22, 9
s_add_u32 s19, s19, s16
s_mov_b32 s16, 1664525
s_mov_b32 s17, 22695477
v_mov_b32 v4, 151588
s_waitcnt vmcnt(2)
v_mul_lo_u32 v10, v10, s16
v_mul_lo_u32 v11, v11, s17
v_add_u32 v10, 1013904223, v10
v_add_u32 v11, 0x9e3779b9, v11
v_mov_b32 v26, v10
v_mov_b32 v27, v11
v_mov_b32 v30, v10
v_mov_b32 v31, v11
s_mov_b32 s25, 262144
s_waitcnt vmcnt(0)
L_pollms:
ds_read_b32 v5, v4
s_waitcnt lgkmcnt(0)
v_readfirstlane_b32 s24, v5
s_nop 0
s_cmp_ge_u32 s24, 10
s_cbranch_scc1 L_pollokms
s_sleep 0
s_branch L_pollms
L_pollokms:
ds_read_b128 v[32:35], v6 offset:0
ds_read_b128 v[36:39], v6 offset:1024
ds_read_b128 v[40:43], v6 offset:2048
ds_read_b128 v[44:47], v6 offset:3072
ds_read_b128 v[48:51], v6 offset:4096
ds_read_b128 v[52:55], v6 offset:5120
ds_read_b128 v[56:59], v6 offset:6144
ds_read_b128 v[60:63], v6 offset:7168
ds_read_b128 v[64:67], v6 offset:8192
ds_read_b128 v[68:71], v6 offset:9216
s_waitcnt lgkmcnt(0)
v_pk_add_f32 v[32:33], v[32:33], v[52:53]
v_pk_add_f32 v[34:35], v[34:35], v[54:55]
v_pk_add_f32 v[36:37], v[36:37], v[56:57]
v_pk_add_f32 v[38:39], v[38:39], v[58:59]
v_pk_add_f32 v[40:41], v[40:41], v[60:61]
v_pk_add_f32 v[42:43], v[42:43], v[62:63]
v_pk_add_f32 v[44:45], v[44:45], v[64:65]
v_pk_add_f32 v[46:47], v[46:47], v[66:67]
v_pk_add_f32 v[48:49], v[48:49], v[68:69]
v_pk_add_f32 v[50:51], v[50:51], v[70:71]
v_pk_add_f32 v[32:33], v[32:33], v[36:37]
v_pk_add_f32 v[34:35], v[34:35], v[38:39]
v_pk_add_f32 v[40:41], v[40:41], v[44:45]
v_pk_add_f32 v[42:43], v[42:43], v[46:47]
v_pk_add_f32 v[32:33], v[32:33], v[48:49]
v_pk_add_f32 v[34:35], v[34:35], v[50:51]
v_pk_add_f32 v[24:25], v[32:33], v[40:41]
v_pk_add_f32 v[28:29], v[34:35], v[42:43]
buffer_store_dwordx4 v[24:27], v14, s[12:15], s19 offen sc1
buffer_store_dwordx4 v[28:31], v14, s[12:15], s19 offen offset:16 sc1
s_lshr_b32 s41, s58, 1
v_lshlrev_b32 v20, 16, v20
v_lshlrev_b32 v21, 16, v21
s_waitcnt vmcnt(0)
L_gather:
buffer_load_dwordx4 v[32:35], v8, s[12:15], 0 offen offset:0 sc1
buffer_load_dwordx4 v[36:39], v8, s[12:15], 0 offen offset:1024 sc1
buffer_load_dwordx4 v[40:43], v8, s[12:15], 0 offen offset:2048 sc1
buffer_load_dwordx4 v[44:47], v8, s[12:15], 0 offen offset:3072 sc1
s_movk_i32 s40, 4096
buffer_load_dwordx4 v[48:51], v8, s[12:15], s40 offen offset:0 sc1
buffer_load_dwordx4 v[52:55], v8, s[12:15], s40 offen offset:1024 sc1
buffer_load_dwordx4 v[56:59], v8, s[12:15], s40 offen offset:2048 sc1
buffer_load_dwordx4 v[60:63], v8, s[12:15], s40 offen offset:3072 sc1
s_movk_i32 s40, 8192
buffer_load_dwordx4 v[64:67], v8, s[12:15], s40 offen offset:0 sc1
buffer_load_dwordx4 v[68:71], v8, s[12:15], s40 offen offset:1024 sc1
buffer_load_dwordx4 v[72:75], v8, s[12:15], s40 offen offset:2048 sc1
buffer_load_dwordx4 v[76:79], v8, s[12:15], s40 offen offset:3072 sc1
s_movk_i32 s40, 12288
buffer_load_dwordx4 v[80:83], v8, s[12:15], s40 offen offset:0 sc1
buffer_load_dwordx4 v[84:87], v8, s[12:15], s40 offen offset:1024 sc1
buffer_load_dwordx4 v[88:91], v8, s[12:15], s40 offen offset:2048 sc1
buffer_load_dwordx4 v[92:95], v8, s[12:15], s40 offen offset:3072 sc1
s_waitcnt vmcnt(0)
s_mov_b64 s[30:31], 0
s_mov_b64 s[42:43], 0
v_cmp_ne_u64 s[32:33], v[10:11], v[34:35]
v_cmp_ne_u64 s[34:35], v[10:11], v[42:43]
v_cmp_ne_u64 s[46:47], v[10:11], v[38:39]
v_cmp_ne_u64 vcc, v[10:11], v[46:47]
s_or_b64 s[30:31], s[30:31], s[32:33]
s_or_b64 s[30:31], s[30:31], s[34:35]
s_or_b64 s[46:47], s[46:47], vcc
s_or_b32 s30, s30, s46
s_or_b32 s42, s42, s47
v_cmp_ne_u64 s[32:33], v[10:11], v[50:51]
v_cmp_ne_u64 s[34:35], v[10:11], v[58:59]
v_cmp_ne_u64 s[46:47], v[10:11], v[54:55]
v_cmp_ne_u64 vcc, v[10:11], v[62:63]
s_or_b64 s[30:31], s[30:31], s[32:33]
s_or_b64 s[30:31], s[30:31], s[34:35]
s_or_b64 s[46:47], s[46:47], vcc
s_or_b32 s30, s30, s46
s_or_b32 s42, s42, s47
v_cmp_ne_u64 s[32:33], v[10:11], v[66:67]
v_cmp_ne_u64 s[34:35], v[10:11], v[74:75]
v_cmp_ne_u64 s[46:47], v[10:11], v[70:71]
v_cmp_ne_u64 vcc, v[10:11], v[78:79]
s_or_b64 s[30:31], s[30:31], s[32:33]
s_or_b64 s[30:31], s[30:31], s[34:35]
s_or_b64 s[46:47], s[46:47], vcc
s_or_b32 s30, s30, s46
s_or_b32 s42, s42, s47
v_cmp_ne_u64 s[32:33], v[10:11], v[82:83]
v_cmp_ne_u64 s[34:35], v[10:11], v[90:91]
v_cmp_ne_u64 s[46:47], v[10:11], v[86:87]
v_cmp_ne_u64 vcc, v[10:11], v[94:95]
s_or_b64 s[30:31], s[30:31], s[32:33]
s_or_b64 s[30:31], s[30:31], s[34:35]
s_or_b64 s[46:47], s[46:47], vcc
s_or_b32 s30, s30, s46
s_or_b32 s42, s42, s47
s_cmp_eq_u64 s[30:31], 0
s_cbranch_scc1 L_gok
s_cmp_eq_u32 s25, 0
s_cbranch_scc1 L_gok
s_sub_u32 s25, s25, 1
s_sleep 2
s_branch L_gather
L_gok:
v_pk_add_f32 v[32:33], v[32:33], v[40:41]
v_pk_add_f32 v[36:37], v[36:37], v[44:45]
v_cvt_pk_bf16_f32 v32, v32, v33
v_cvt_pk_bf16_f32 v33, v36, v37
ds_write_b16 v7, v32 offset:0
ds_write_b16_d16_hi v7, v32 offset:8
ds_write_b16 v7, v33 offset:256
ds_write_b16_d16_hi v7, v33 offset:264
v_pk_add_f32 v[48:49], v[48:49], v[56:57]
v_pk_add_f32 v[52:53], v[52:53], v[60:61]
v_cvt_pk_bf16_f32 v48, v48, v49
v_cvt_pk_bf16_f32 v49, v52, v53
ds_write_b16 v7, v48 offset:512
ds_write_b16_d16_hi v7, v48 offset:520
ds_write_b16 v7, v49 offset:768
ds_write_b16_d16_hi v7, v49 offset:776
v_pk_add_f32 v[64:65], v[64:65], v[72:73]
v_pk_add_f32 v[68:69], v[68:69], v[76:77]
v_cvt_pk_bf16_f32 v64, v64, v65
v_cvt_pk_bf16_f32 v65, v68, v69
ds_write_b16 v7, v64 offset:1024
ds_write_b16_d16_hi v7, v64 offset:1032
ds_write_b16 v7, v65 offset:1280
ds_write_b16_d16_hi v7, v65 offset:1288
v_pk_add_f32 v[80:81], v[80:81], v[88:89]
v_pk_add_f32 v[84:85], v[84:85], v[92:93]
v_cvt_pk_bf16_f32 v80, v80, v81
v_cvt_pk_bf16_f32 v81, v84, v85
ds_write_b16 v7, v80 offset:1536
ds_write_b16_d16_hi v7, v80 offset:1544
ds_write_b16 v7, v81 offset:1792
ds_write_b16_d16_hi v7, v81 offset:1800
v_mov_b32 v4, 151592
v_mov_b32 v5, 4
s_waitcnt lgkmcnt(0)
ds_write_b32 v4, v5
s_setprio 0
s_cmp_lg_u32 s41, 1
s_cbranch_scc1 L_hs1
v_mov_b32 v36, v52
v_mov_b32 v37, v53
L_hs1:
s_cmp_lg_u32 s41, 2
s_cbranch_scc1 L_hs2
v_mov_b32 v36, v68
v_mov_b32 v37, v69
L_hs2:
s_cmp_lg_u32 s41, 3
s_cbranch_scc1 L_hs3
v_mov_b32 v36, v84
v_mov_b32 v37, v85
L_hs3:
s_mov_b32 exec_lo, 0
s_cmp_eq_u32 s42, 0
s_cbranch_scc1 L_ghok
s_lshl_b32 s40, s41, 12
L_gh:
s_sleep 8
buffer_load_dwordx4 v[36:39], v8, s[12:15], s40 offen offset:1024 sc1
buffer_load_dwordx4 v[44:47], v8, s[12:15], s40 offen offset:3072 sc1
s_waitcnt vmcnt(0)
v_cmp_ne_u64 s[30:31], v[10:11], v[38:39]
v_cmp_ne_u64 s[32:33], v[10:11], v[46:47]
v_pk_add_f32 v[36:37], v[36:37], v[44:45]
s_nop 0
s_or_b64 s[30:31], s[30:31], s[32:33]
s_cbranch_scc0 L_ghok
s_cmp_eq_u32 s25, 0
s_cbranch_scc1 L_ghok
s_sub_u32 s25, s25, 1
s_branch L_gh
L_ghok:
v_cvt_pk_bf16_f32 v36, v36, v36
v_and_b32 v36, 0xffff0000, v36
v_cvt_pk_bf16_f32 v37, v37, v37
v_and_b32 v37, 0xffff0000, v37
v_add_f32 v36, v36, v20
v_add_f32 v37, v37, v21
v_cvt_pk_bf16_f32 v36, v36, v36
v_and_b32 v36, 0xffff0000, v36
v_cvt_pk_bf16_f32 v37, v37, v37
v_and_b32 v37, 0xffff0000, v37
v_max_f32 v36, 0, v36
v_max_f32 v37, 0, v37
v_mul_f32 v36, v36, v36
v_mul_f32 v37, v37, v37
v_cvt_pk_bf16_f32 v36, v36, v37
ds_write_b16 v7, v36 offset:256
ds_write_b16_d16_hi v7, v36 offset:264
s_mov_b64 exec, -1
v_mov_b32 v5, 5
s_waitcnt lgkmcnt(0)
ds_write_b32 v4, v5
s_cmp_lg_u32 s58, 0
s_cbranch_scc1 L_noe
s_mov_b64 exec, 1
buffer_store_dwordx2 v[10:11], v9, s[8:11], 0 offen sc1
s_mov_b64 exec, -1
L_noe:
s_waitcnt lgkmcnt(0)
s_endpgm
L_crest:
v_lshrrev_b32 v2, 3, v0
v_and_b32 v3, 7, v0
v_mul_u32_u24 v4, 384, v2
v_lshl_add_u32 v4, v3, 4, v4
v_and_b32 v9, 3, v3
v_cmp_eq_u32 s[30:31], 1, v9
v_cmp_eq_u32 s[32:33], 2, v9
v_cmp_eq_u32 s[34:35], 3, v9
s_lshl_b32 s16, s18, 10
s_add_u32 s16, s16, 122880
v_lshlrev_b32 v107, 7, v2
v_lshl_add_u32 v107, v9, 5, v107
v_add_u32 v107, s16, v107
v_mov_b32 v7, 151552
s_lshl_b32 s16, s18, 2
s_add_u32 s16, s16, 151568
v_mov_b32 v8, s16
s_mul_i32 s21, s18, 12288
s_add_u32 s22, s18, 1
s_mov_b32 s19, 0
s_mov_b32 s27, 0
s_mov_b32 s28, 1033096506
s_mov_b32 s29, 1069066811
v_lshlrev_b32 v108, 4, v3
v_add_u32 v108, 149504, v108
v_lshlrev_b32 v105, 5, v3
v_bfe_u32 v96, v0, 4, 1
v_lshl_add_u32 v105, v96, 3, v105
v_bfe_u32 v96, v0, 5, 1
v_lshl_add_u32 v105, v96, 4, v105
s_lshl_b32 s16, s18, 10
s_add_u32 s16, s16, 122880
v_add_u32 v105, s16, v105
v_add_u32 v109, 112, v8
v_mov_b32 v110, 151680
s_lshl_b32 s41, s5, 3
s_add_u32 s41, s41, s58
s_lshl_b32 s41, s41, 3
s_add_u32 s12, s88, 6291456
s_addc_u32 s13, s89, 0
s_movk_i32 s14, 8192
s_mov_b32 s15, 0x20000
L_step:
s_cmp_ge_u32 s27, s22
s_cbranch_scc1 L_pollokk0
L_pollk0:
ds_read_b32 v9, v7
s_waitcnt lgkmcnt(0)
v_readfirstlane_b32 s27, v9
s_nop 0
s_cmp_ge_u32 s27, s22
s_cbranch_scc1 L_pollokk0
s_sleep 1
s_branch L_pollk0
L_pollokk0:
v_add_u32 v5, s21, v4
ds_read_b128 v[48:51], v5 offset:0
ds_read_b128 v[52:55], v5 offset:128
ds_read_b128 v[56:59], v5 offset:256
ds_read_b128 v[60:63], v5 offset:3072
ds_read_b128 v[64:67], v5 offset:3200
ds_read_b128 v[68:71], v5 offset:3328
ds_read_b128 v[72:75], v5 offset:6144
ds_read_b128 v[76:79], v5 offset:6272
ds_read_b128 v[80:83], v5 offset:6400
ds_read_b128 v[84:87], v5 offset:9216
ds_read_b128 v[88:91], v5 offset:9344
ds_read_b128 v[92:95], v5 offset:9472
v_mov_b32 v10, 0xff800000
v_mov_b32 v6, v107
v_mov_b32 v96, 151592
s_waitcnt lgkmcnt(0)
s_add_u32 s19, s19, 1
v_mov_b32 v9, s19
ds_write_b32 v8, v9
s_add_u32 s22, s22, 4
s_add_u32 s21, s21, 49152
s_cmp_ge_u32 s21, 122880
s_cselect_b32 s16, 122880, 0
s_sub_u32 s21, s21, s16
L_pollq:
ds_read_b32 v97, v96
s_waitcnt lgkmcnt(0)
v_readfirstlane_b32 s24, v97
s_nop 0
s_cmp_ge_u32 s24, 4
s_cbranch_scc1 L_pollokq
s_sleep 1
s_branch L_pollq
L_pollokq:
ds_read_b128 v[12:15], v108 offset:0
ds_read_b128 v[16:19], v108 offset:128
ds_read_b128 v[20:23], v108 offset:256
v_add_u32 v108, 512, v108
s_waitcnt lgkmcnt(0)
s_branch L_cK1
L_cK:
s_cmp_ge_u32 s27, s22
s_cbranch_scc1 L_pollokk
L_pollk:
ds_read_b32 v9, v7
s_waitcnt lgkmcnt(0)
v_readfirstlane_b32 s27, v9
s_nop 0
s_cmp_ge_u32 s27, s22
s_cbranch_scc1 L_pollokk
s_sleep 1
s_branch L_pollk
L_pollokk:
v_add_u32 v5, s21, v4
ds_read_b128 v[48:51], v5 offset:0
ds_read_b128 v[52:55], v5 offset:128
ds_read_b128 v[56:59], v5 offset:256
ds_read_b128 v[60:63], v5 offset:3072
ds_read_b128 v[64:67], v5 offset:3200
ds_read_b128 v[68:71], v5 offset:3328
ds_read_b128 v[72:75], v5 offset:6144
ds_read_b128 v[76:79], v5 offset:6272
ds_read_b128 v[80:83], v5 offset:6400
ds_read_b128 v[84:87], v5 offset:9216
ds_read_b128 v[88:91], v5 offset:9344
ds_read_b128 v[92:95], v5 offset:9472
s_waitcnt lgkmcnt(0)
s_add_u32 s19, s19, 1
v_mov_b32 v9, s19
ds_write_b32 v8, v9
s_add_u32 s22, s22, 4
s_add_u32 s21, s21, 49152
s_cmp_ge_u32 s21, 122880
s_cselect_b32 s16, 122880, 0
s_sub_u32 s21, s21, s16
L_cK1:
v_dot2_f32_bf16 v96, v48, v12, 0
v_dot2_f32_bf16 v97, v49, v13, 0
v_dot2_f32_bf16 v96, v50, v14, v96
v_dot2_f32_bf16 v97, v51, v15, v97
v_dot2_f32_bf16 v96, v52, v16, v96
v_dot2_f32_bf16 v97, v53, v17, v97
v_dot2_f32_bf16 v96, v54, v18, v96
v_dot2_f32_bf16 v97, v55, v19, v97
v_dot2_f32_bf16 v96, v56, v20, v96
v_dot2_f32_bf16 v97, v57, v21, v97
v_dot2_f32_bf16 v96, v58, v22, v96
v_dot2_f32_bf16 v97, v59, v23, v97
v_dot2_f32_bf16 v98, v60, v12, 0
v_dot2_f32_bf16 v99, v61, v13, 0
v_dot2_f32_bf16 v98, v62, v14, v98
v_dot2_f32_bf16 v99, v63, v15, v99
v_dot2_f32_bf16 v98, v64, v16, v98
v_dot2_f32_bf16 v99, v65, v17, v99
v_dot2_f32_bf16 v98, v66, v18, v98
v_dot2_f32_bf16 v99, v67, v19, v99
v_dot2_f32_bf16 v98, v68, v20, v98
v_dot2_f32_bf16 v99, v69, v21, v99
v_dot2_f32_bf16 v98, v70, v22, v98
v_dot2_f32_bf16 v99, v71, v23, v99
v_dot2_f32_bf16 v100, v72, v12, 0
v_dot2_f32_bf16 v101, v73, v13, 0
v_dot2_f32_bf16 v100, v74, v14, v100
v_dot2_f32_bf16 v101, v75, v15, v101
v_dot2_f32_bf16 v100, v76, v16, v100
v_dot2_f32_bf16 v101, v77, v17, v101
v_dot2_f32_bf16 v100, v78, v18, v100
v_dot2_f32_bf16 v101, v79, v19, v101
v_dot2_f32_bf16 v100, v80, v20, v100
v_dot2_f32_bf16 v101, v81, v21, v101
v_dot2_f32_bf16 v100, v82, v22, v100
v_dot2_f32_bf16 v101, v83, v23, v101
v_dot2_f32_bf16 v102, v84, v12, 0
v_dot2_f32_bf16 v103, v85, v13, 0
v_dot2_f32_bf16 v102, v86, v14, v102
v_dot2_f32_bf16 v103, v87, v15, v103
v_dot2_f32_bf16 v102, v88, v16, v102
v_dot2_f32_bf16 v103, v89, v17, v103
v_dot2_f32_bf16 v102, v90, v18, v102
v_dot2_f32_bf16 v103, v91, v19, v103
v_dot2_f32_bf16 v102, v92, v20, v102
v_dot2_f32_bf16 v103, v93, v21, v103
v_dot2_f32_bf16 v102, v94, v22, v102
v_dot2_f32_bf16 v103, v95, v23, v103
s_nop 2
v_add_f32 v96, v96, v97
v_add_f32 v98, v98, v99
v_add_f32 v100, v100, v101
v_add_f32 v102, v102, v103
v_add_f32_dpp v96, v96, v96 quad_perm:[1,0,3,2] row_mask:0xf bank_mask:0xf
v_add_f32_dpp v98, v98, v98 quad_perm:[1,0,3,2] row_mask:0xf bank_mask:0xf
v_add_f32_dpp v100, v100, v100 quad_perm:[1,0,3,2] row_mask:0xf bank_mask:0xf
v_add_f32_dpp v102, v102, v102 quad_perm:[1,0,3,2] row_mask:0xf bank_mask:0xf
v_add_f32_dpp v96, v96, v96 quad_perm:[2,3,0,1] row_mask:0xf bank_mask:0xf
v_add_f32_dpp v98, v98, v98 quad_perm:[2,3,0,1] row_mask:0xf bank_mask:0xf
v_add_f32_dpp v100, v100, v100 quad_perm:[2,3,0,1] row_mask:0xf bank_mask:0xf
v_add_f32_dpp v102, v102, v102 quad_perm:[2,3,0,1] row_mask:0xf bank_mask:0xf
v_add_f32_dpp v96, v96, v96 row_half_mirror row_mask:0xf bank_mask:0xf
v_add_f32_dpp v98, v98, v98 row_half_mirror row_mask:0xf bank_mask:0xf
v_add_f32_dpp v100, v100, v100 row_half_mirror row_mask:0xf bank_mask:0xf
v_add_f32_dpp v102, v102, v102 row_half_mirror row_mask:0xf bank_mask:0xf
v_cndmask_b32 v96, v96, v98, s[30:31]
v_cndmask_b32 v96, v96, v100, s[32:33]
v_cndmask_b32 v96, v96, v102, s[34:35]
v_cvt_pk_bf16_f32 v96, v96, v96
v_and_b32 v96, 0xffff0000, v96
v_mul_f32 v96, s28, v96
v_cvt_pk_bf16_f32 v96, v96, v96
v_and_b32 v96, 0xffff0000, v96
v_max_f32 v10, v10, v96
ds_write_b32 v6, v96
v_add_u32 v6, 4, v6
s_and_b32 s16, s19, 7
s_cbranch_scc1 L_cK
ds_read_b128 v[96:99], v107
ds_read_b128 v[100:103], v107 offset:16
s_nop 1
v_max_f32_dpp v10, v10, v10 quad_perm:[1,0,3,2] row_mask:0xf bank_mask:0xf
s_nop 1
v_max_f32_dpp v10, v10, v10 quad_perm:[2,3,0,1] row_mask:0xf bank_mask:0xf
s_nop 1
v_max_f32_dpp v10, v10, v10 row_half_mirror row_mask:0xf bank_mask:0xf
s_nop 1
v_max_f32_dpp v10, v10, v10 row_mirror row_mask:0xf bank_mask:0xf
v_mov_b32 v9, v10
s_nop 1
v_permlane16_swap_b32 v10, v9
s_nop 0
v_max_f32 v10, v10, v9
v_mov_b32 v9, v10
s_nop 1
v_permlane32_swap_b32 v10, v9
s_nop 0
v_max_f32 v10, v10, v9
v_mul_f32 v104, s29, v10
s_waitcnt lgkmcnt(0)
v_fma_f32 v96, v96, s29, -v104
v_fma_f32 v97, v97, s29, -v104
v_fma_f32 v98, v98, s29, -v104
v_fma_f32 v99, v99, s29, -v104
v_fma_f32 v100, v100, s29, -v104
v_fma_f32 v101, v101, s29, -v104
v_fma_f32 v102, v102, s29, -v104
v_fma_f32 v103, v103, s29, -v104
v_exp_f32 v96, v96
v_exp_f32 v97, v97
v_exp_f32 v98, v98
v_exp_f32 v99, v99
v_exp_f32 v100, v100
v_exp_f32 v101, v101
v_exp_f32 v102, v102
v_exp_f32 v103, v103
s_nop 0
v_add_f32 v11, v96, v97
v_add_f32 v104, v98, v99
v_add_f32 v9, v100, v101
v_add_f32 v6, v102, v103
v_add_f32 v11, v11, v104
v_add_f32 v9, v9, v6
v_add_f32 v11, v11, v9
v_cvt_pk_bf16_f32 v96, v96, 0
v_cvt_pk_bf16_f32 v97, v97, 0
v_cvt_pk_bf16_f32 v98, v98, 0
v_cvt_pk_bf16_f32 v99, v99, 0
v_cvt_pk_bf16_f32 v100, v100, 0
v_cvt_pk_bf16_f32 v101, v101, 0
v_cvt_pk_bf16_f32 v102, v102, 0
v_cvt_pk_bf16_f32 v103, v103, 0
ds_write_b128 v107, v[96:99]
ds_write_b128 v107, v[100:103] offset:16
s_nop 1
v_add_f32_dpp v11, v11, v11 quad_perm:[1,0,3,2] row_mask:0xf bank_mask:0xf
s_nop 1
v_add_f32_dpp v11, v11, v11 quad_perm:[2,3,0,1] row_mask:0xf bank_mask:0xf
s_nop 1
v_add_f32_dpp v11, v11, v11 row_half_mirror row_mask:0xf bank_mask:0xf
s_nop 1
v_add_f32_dpp v11, v11, v11 row_mirror row_mask:0xf bank_mask:0xf
v_mov_b32 v9, v11
s_nop 1
v_permlane16_swap_b32 v11, v9
s_nop 0
v_add_f32 v11, v11, v9
v_mov_b32 v9, v11
s_nop 1
v_permlane32_swap_b32 v11, v9
s_nop 0
v_add_f32 v11, v11, v9
v_mul_f32 v11, 0.5, v11
ds_write_b32 v109, v10
ds_write_b32 v109, v11 offset:16
v_add_u32 v107, 4096, v107
v_add_u32 v109, 32, v109
s_cmp_lt_u32 s19, 32
s_cbranch_scc1 L_step
s_waitcnt lgkmcnt(0)
v_mov_b32 v96, 151596
v_mov_b32 v97, 1
s_mov_b64 exec, 1
ds_add_u32 v96, v97
s_mov_b64 exec, -1
v_subrev_u32 v107, 16384, v107
v_subrev_u32 v109, 128, v109
L_vstep:
v_mov_b32 v24, 0
v_mov_b32 v25, 0
v_mov_b32 v26, 0
v_mov_b32 v27, 0
v_mov_b32 v28, 0
v_mov_b32 v29, 0
v_mov_b32 v30, 0
v_mov_b32 v31, 0
v_mov_b32 v32, 0
v_mov_b32 v33, 0
v_mov_b32 v34, 0
v_mov_b32 v35, 0
v_mov_b32 v36, 0
v_mov_b32 v37, 0
v_mov_b32 v38, 0
v_mov_b32 v39, 0
v_mov_b32 v40, 0
v_mov_b32 v41, 0
v_mov_b32 v42, 0
v_mov_b32 v43, 0
v_mov_b32 v44, 0
v_mov_b32 v45, 0
v_mov_b32 v46, 0
v_mov_b32 v47, 0
v_mov_b32 v6, v107
L_cV:
ds_read_b32 v97, v6
s_cmp_ge_u32 s27, s22
s_cbranch_scc1 L_pollokv
L_pollv:
ds_read_b32 v9, v7
s_waitcnt lgkmcnt(0)
v_readfirstlane_b32 s27, v9
s_nop 0
s_cmp_ge_u32 s27, s22
s_cbranch_scc1 L_pollokv
s_sleep 1
s_branch L_pollv
L_pollokv:
v_add_u32 v5, s21, v4
ds_read_b128 v[48:51], v5 offset:0
ds_read_b128 v[52:55], v5 offset:128
ds_read_b128 v[56:59], v5 offset:256
ds_read_b128 v[60:63], v5 offset:3072
ds_read_b128 v[64:67], v5 offset:3200
ds_read_b128 v[68:71], v5 offset:3328
ds_read_b128 v[72:75], v5 offset:6144
ds_read_b128 v[76:79], v5 offset:6272
ds_read_b128 v[80:83], v5 offset:6400
ds_read_b128 v[84:87], v5 offset:9216
ds_read_b128 v[88:91], v5 offset:9344
ds_read_b128 v[92:95], v5 offset:9472
v_add_u32 v6, 4, v6
s_waitcnt lgkmcnt(12)
v_lshlrev_b32 v98, 16, v97
s_waitcnt lgkmcnt(9)
s_nop 0
v_dot2c_f32_bf16_dpp v24, v97, v48 quad_perm:[0,0,0,0] row_mask:0xf bank_mask:0xf
v_dot2c_f32_bf16_dpp v25, v98, v48 quad_perm:[0,0,0,0] row_mask:0xf bank_mask:0xf
v_dot2c_f32_bf16_dpp v26, v97, v49 quad_perm:[0,0,0,0] row_mask:0xf bank_mask:0xf
v_dot2c_f32_bf16_dpp v27, v98, v49 quad_perm:[0,0,0,0] row_mask:0xf bank_mask:0xf
v_dot2c_f32_bf16_dpp v28, v97, v50 quad_perm:[0,0,0,0] row_mask:0xf bank_mask:0xf
v_dot2c_f32_bf16_dpp v29, v98, v50 quad_perm:[0,0,0,0] row_mask:0xf bank_mask:0xf
v_dot2c_f32_bf16_dpp v30, v97, v51 quad_perm:[0,0,0,0] row_mask:0xf bank_mask:0xf
v_dot2c_f32_bf16_dpp v31, v98, v51 quad_perm:[0,0,0,0] row_mask:0xf bank_mask:0xf
v_dot2c_f32_bf16_dpp v32, v97, v52 quad_perm:[0,0,0,0] row_mask:0xf bank_mask:0xf
v_dot2c_f32_bf16_dpp v33, v98, v52 quad_perm:[0,0,0,0] row_mask:0xf bank_mask:0xf
v_dot2c_f32_bf16_dpp v34, v97, v53 quad_perm:[0,0,0,0] row_mask:0xf bank_mask:0xf
v_dot2c_f32_bf16_dpp v35, v98, v53 quad_perm:[0,0,0,0] row_mask:0xf bank_mask:0xf
v_dot2c_f32_bf16_dpp v36, v97, v54 quad_perm:[0,0,0,0] row_mask:0xf bank_mask:0xf
v_dot2c_f32_bf16_dpp v37, v98, v54 quad_perm:[0,0,0,0] row_mask:0xf bank_mask:0xf
v_dot2c_f32_bf16_dpp v38, v97, v55 quad_perm:[0,0,0,0] row_mask:0xf bank_mask:0xf
v_dot2c_f32_bf16_dpp v39, v98, v55 quad_perm:[0,0,0,0] row_mask:0xf bank_mask:0xf
v_dot2c_f32_bf16_dpp v40, v97, v56 quad_perm:[0,0,0,0] row_mask:0xf bank_mask:0xf
v_dot2c_f32_bf16_dpp v41, v98, v56 quad_perm:[0,0,0,0] row_mask:0xf bank_mask:0xf
v_dot2c_f32_bf16_dpp v42, v97, v57 quad_perm:[0,0,0,0] row_mask:0xf bank_mask:0xf
v_dot2c_f32_bf16_dpp v43, v98, v57 quad_perm:[0,0,0,0] row_mask:0xf bank_mask:0xf
v_dot2c_f32_bf16_dpp v44, v97, v58 quad_perm:[0,0,0,0] row_mask:0xf bank_mask:0xf
v_dot2c_f32_bf16_dpp v45, v98, v58 quad_perm:[0,0,0,0] row_mask:0xf bank_mask:0xf
v_dot2c_f32_bf16_dpp v46, v97, v59 quad_perm:[0,0,0,0] row_mask:0xf bank_mask:0xf
v_dot2c_f32_bf16_dpp v47, v98, v59 quad_perm:[0,0,0,0] row_mask:0xf bank_mask:0xf
s_waitcnt lgkmcnt(6)
v_dot2c_f32_bf16_dpp v24, v97, v60 quad_perm:[1,1,1,1] row_mask:0xf bank_mask:0xf
v_dot2c_f32_bf16_dpp v25, v98, v60 quad_perm:[1,1,1,1] row_mask:0xf bank_mask:0xf
v_dot2c_f32_bf16_dpp v26, v97, v61 quad_perm:[1,1,1,1] row_mask:0xf bank_mask:0xf
v_dot2c_f32_bf16_dpp v27, v98, v61 quad_perm:[1,1,1,1] row_mask:0xf bank_mask:0xf
v_dot2c_f32_bf16_dpp v28, v97, v62 quad_perm:[1,1,1,1] row_mask:0xf bank_mask:0xf
v_dot2c_f32_bf16_dpp v29, v98, v62 quad_perm:[1,1,1,1] row_mask:0xf bank_mask:0xf
v_dot2c_f32_bf16_dpp v30, v97, v63 quad_perm:[1,1,1,1] row_mask:0xf bank_mask:0xf
v_dot2c_f32_bf16_dpp v31, v98, v63 quad_perm:[1,1,1,1] row_mask:0xf bank_mask:0xf
v_dot2c_f32_bf16_dpp v32, v97, v64 quad_perm:[1,1,1,1] row_mask:0xf bank_mask:0xf
v_dot2c_f32_bf16_dpp v33, v98, v64 quad_perm:[1,1,1,1] row_mask:0xf bank_mask:0xf
v_dot2c_f32_bf16_dpp v34, v97, v65 quad_perm:[1,1,1,1] row_mask:0xf bank_mask:0xf
v_dot2c_f32_bf16_dpp v35, v98, v65 quad_perm:[1,1,1,1] row_mask:0xf bank_mask:0xf
v_dot2c_f32_bf16_dpp v36, v97, v66 quad_perm:[1,1,1,1] row_mask:0xf bank_mask:0xf
v_dot2c_f32_bf16_dpp v37, v98, v66 quad_perm:[1,1,1,1] row_mask:0xf bank_mask:0xf
v_dot2c_f32_bf16_dpp v38, v97, v67 quad_perm:[1,1,1,1] row_mask:0xf bank_mask:0xf
v_dot2c_f32_bf16_dpp v39, v98, v67 quad_perm:[1,1,1,1] row_mask:0xf bank_mask:0xf
v_dot2c_f32_bf16_dpp v40, v97, v68 quad_perm:[1,1,1,1] row_mask:0xf bank_mask:0xf
v_dot2c_f32_bf16_dpp v41, v98, v68 quad_perm:[1,1,1,1] row_mask:0xf bank_mask:0xf
v_dot2c_f32_bf16_dpp v42, v97, v69 quad_perm:[1,1,1,1] row_mask:0xf bank_mask:0xf
v_dot2c_f32_bf16_dpp v43, v98, v69 quad_perm:[1,1,1,1] row_mask:0xf bank_mask:0xf
v_dot2c_f32_bf16_dpp v44, v97, v70 quad_perm:[1,1,1,1] row_mask:0xf bank_mask:0xf
v_dot2c_f32_bf16_dpp v45, v98, v70 quad_perm:[1,1,1,1] row_mask:0xf bank_mask:0xf
v_dot2c_f32_bf16_dpp v46, v97, v71 quad_perm:[1,1,1,1] row_mask:0xf bank_mask:0xf
v_dot2c_f32_bf16_dpp v47, v98, v71 quad_perm:[1,1,1,1] row_mask:0xf bank_mask:0xf
s_waitcnt lgkmcnt(3)
v_dot2c_f32_bf16_dpp v24, v97, v72 quad_perm:[2,2,2,2] row_mask:0xf bank_mask:0xf
v_dot2c_f32_bf16_dpp v25, v98, v72 quad_perm:[2,2,2,2] row_mask:0xf bank_mask:0xf
v_dot2c_f32_bf16_dpp v26, v97, v73 quad_perm:[2,2,2,2] row_mask:0xf bank_mask:0xf
v_dot2c_f32_bf16_dpp v27, v98, v73 quad_perm:[2,2,2,2] row_mask:0xf bank_mask:0xf
v_dot2c_f32_bf16_dpp v28, v97, v74 quad_perm:[2,2,2,2] row_mask:0xf bank_mask:0xf
v_dot2c_f32_bf16_dpp v29, v98, v74 quad_perm:[2,2,2,2] row_mask:0xf bank_mask:0xf
v_dot2c_f32_bf16_dpp v30, v97, v75 quad_perm:[2,2,2,2] row_mask:0xf bank_mask:0xf
v_dot2c_f32_bf16_dpp v31, v98, v75 quad_perm:[2,2,2,2] row_mask:0xf bank_mask:0xf
v_dot2c_f32_bf16_dpp v32, v97, v76 quad_perm:[2,2,2,2] row_mask:0xf bank_mask:0xf
v_dot2c_f32_bf16_dpp v33, v98, v76 quad_perm:[2,2,2,2] row_mask:0xf bank_mask:0xf
v_dot2c_f32_bf16_dpp v34, v97, v77 quad_perm:[2,2,2,2] row_mask:0xf bank_mask:0xf
v_dot2c_f32_bf16_dpp v35, v98, v77 quad_perm:[2,2,2,2] row_mask:0xf bank_mask:0xf
v_dot2c_f32_bf16_dpp v36, v97, v78 quad_perm:[2,2,2,2] row_mask:0xf bank_mask:0xf
v_dot2c_f32_bf16_dpp v37, v98, v78 quad_perm:[2,2,2,2] row_mask:0xf bank_mask:0xf
v_dot2c_f32_bf16_dpp v38, v97, v79 quad_perm:[2,2,2,2] row_mask:0xf bank_mask:0xf
v_dot2c_f32_bf16_dpp v39, v98, v79 quad_perm:[2,2,2,2] row_mask:0xf bank_mask:0xf
v_dot2c_f32_bf16_dpp v40, v97, v80 quad_perm:[2,2,2,2] row_mask:0xf bank_mask:0xf
v_dot2c_f32_bf16_dpp v41, v98, v80 quad_perm:[2,2,2,2] row_mask:0xf bank_mask:0xf
v_dot2c_f32_bf16_dpp v42, v97, v81 quad_perm:[2,2,2,2] row_mask:0xf bank_mask:0xf
v_dot2c_f32_bf16_dpp v43, v98, v81 quad_perm:[2,2,2,2] row_mask:0xf bank_mask:0xf
v_dot2c_f32_bf16_dpp v44, v97, v82 quad_perm:[2,2,2,2] row_mask:0xf bank_mask:0xf
v_dot2c_f32_bf16_dpp v45, v98, v82 quad_perm:[2,2,2,2] row_mask:0xf bank_mask:0xf
v_dot2c_f32_bf16_dpp v46, v97, v83 quad_perm:[2,2,2,2] row_mask:0xf bank_mask:0xf
v_dot2c_f32_bf16_dpp v47, v98, v83 quad_perm:[2,2,2,2] row_mask:0xf bank_mask:0xf
s_waitcnt lgkmcnt(0)
s_add_u32 s19, s19, 1
v_mov_b32 v9, s19
ds_write_b32 v8, v9
s_add_u32 s22, s22, 4
s_add_u32 s21, s21, 49152
s_cmp_ge_u32 s21, 122880
s_cselect_b32 s16, 122880, 0
s_sub_u32 s21, s21, s16
v_dot2c_f32_bf16_dpp v24, v97, v84 quad_perm:[3,3,3,3] row_mask:0xf bank_mask:0xf
v_dot2c_f32_bf16_dpp v25, v98, v84 quad_perm:[3,3,3,3] row_mask:0xf bank_mask:0xf
v_dot2c_f32_bf16_dpp v26, v97, v85 quad_perm:[3,3,3,3] row_mask:0xf bank_mask:0xf
v_dot2c_f32_bf16_dpp v27, v98, v85 quad_perm:[3,3,3,3] row_mask:0xf bank_mask:0xf
v_dot2c_f32_bf16_dpp v28, v97, v86 quad_perm:[3,3,3,3] row_mask:0xf bank_mask:0xf
v_dot2c_f32_bf16_dpp v29, v98, v86 quad_perm:[3,3,3,3] row_mask:0xf bank_mask:0xf
v_dot2c_f32_bf16_dpp v30, v97, v87 quad_perm:[3,3,3,3] row_mask:0xf bank_mask:0xf
v_dot2c_f32_bf16_dpp v31, v98, v87 quad_perm:[3,3,3,3] row_mask:0xf bank_mask:0xf
v_dot2c_f32_bf16_dpp v32, v97, v88 quad_perm:[3,3,3,3] row_mask:0xf bank_mask:0xf
v_dot2c_f32_bf16_dpp v33, v98, v88 quad_perm:[3,3,3,3] row_mask:0xf bank_mask:0xf
v_dot2c_f32_bf16_dpp v34, v97, v89 quad_perm:[3,3,3,3] row_mask:0xf bank_mask:0xf
v_dot2c_f32_bf16_dpp v35, v98, v89 quad_perm:[3,3,3,3] row_mask:0xf bank_mask:0xf
v_dot2c_f32_bf16_dpp v36, v97, v90 quad_perm:[3,3,3,3] row_mask:0xf bank_mask:0xf
v_dot2c_f32_bf16_dpp v37, v98, v90 quad_perm:[3,3,3,3] row_mask:0xf bank_mask:0xf
v_dot2c_f32_bf16_dpp v38, v97, v91 quad_perm:[3,3,3,3] row_mask:0xf bank_mask:0xf
v_dot2c_f32_bf16_dpp v39, v98, v91 quad_perm:[3,3,3,3] row_mask:0xf bank_mask:0xf
v_dot2c_f32_bf16_dpp v40, v97, v92 quad_perm:[3,3,3,3] row_mask:0xf bank_mask:0xf
v_dot2c_f32_bf16_dpp v41, v98, v92 quad_perm:[3,3,3,3] row_mask:0xf bank_mask:0xf
v_dot2c_f32_bf16_dpp v42, v97, v93 quad_perm:[3,3,3,3] row_mask:0xf bank_mask:0xf
v_dot2c_f32_bf16_dpp v43, v98, v93 quad_perm:[3,3,3,3] row_mask:0xf bank_mask:0xf
v_dot2c_f32_bf16_dpp v44, v97, v94 quad_perm:[3,3,3,3] row_mask:0xf bank_mask:0xf
v_dot2c_f32_bf16_dpp v45, v98, v94 quad_perm:[3,3,3,3] row_mask:0xf bank_mask:0xf
v_dot2c_f32_bf16_dpp v46, v97, v95 quad_perm:[3,3,3,3] row_mask:0xf bank_mask:0xf
v_dot2c_f32_bf16_dpp v47, v98, v95 quad_perm:[3,3,3,3] row_mask:0xf bank_mask:0xf
s_and_b32 s16, s19, 7
s_cmp_lg_u32 s16, 2
s_cbranch_scc1 L_cV2
v_mov_b32 v96, 151596
L_pollf:
ds_read_b32 v97, v96
s_waitcnt lgkmcnt(0)
v_readfirstlane_b32 s24, v97
s_nop 0
s_cmp_ge_u32 s24, 4
s_cbranch_scc1 L_pollokf
s_sleep 1
s_branch L_pollf
L_pollokf:
ds_read_b128 v[96:99], v110
ds_read_b128 v[100:103], v110 offset:16
ds_read_b32 v10, v109
s_waitcnt lgkmcnt(0)
v_max3_f32 v112, v96, v97, v98
v_max_f32 v112, v112, v99
v_mul_f32 v104, s29, v112
v_fma_f32 v96, v96, s29, -v104
v_fma_f32 v97, v97, s29, -v104
v_fma_f32 v98, v98, s29, -v104
v_fma_f32 v99, v99, s29, -v104
v_fma_f32 v106, v10, s29, -v104
v_exp_f32 v96, v96
v_exp_f32 v97, v97
v_exp_f32 v98, v98
v_exp_f32 v99, v99
v_exp_f32 v106, v106
v_mul_f32 v113, v96, v100
v_fmac_f32 v113, v97, v101
v_fmac_f32 v113, v98, v102
v_fmac_f32 v113, v99, v103
v_rcp_f32 v96, v113
s_nop 0
v_fma_f32 v97, -v113, v96, 1.0
v_fmac_f32 v96, v97, v96
v_mul_f32 v106, v106, v96
s_cmp_lg_u32 s18, 0
s_cbranch_scc1 L_cV
v_mov_b32 v96, s41
s_mov_b64 exec, 1
buffer_store_dwordx2 v[112:113], v96, s[12:15], 0 offen
s_mov_b64 exec, -1
s_branch L_cV
L_cV2:
s_cmp_lg_u32 s16, 0
s_cbranch_scc1 L_cV
s_nop 2
v_permlane32_swap_b32 v24, v28
v_permlane32_swap_b32 v25, v29
v_permlane32_swap_b32 v26, v30
v_permlane32_swap_b32 v27, v31
v_permlane32_swap_b32 v32, v36
v_permlane32_swap_b32 v33, v37
v_permlane32_swap_b32 v34, v38
v_permlane32_swap_b32 v35, v39
v_permlane32_swap_b32 v40, v44
v_permlane32_swap_b32 v41, v45
v_permlane32_swap_b32 v42, v46
v_permlane32_swap_b32 v43, v47
s_nop 0
v_add_f32 v24, v24, v28
v_add_f32 v25, v25, v29
v_add_f32 v26, v26, v30
v_add_f32 v27, v27, v31
v_add_f32 v32, v32, v36
v_add_f32 v33, v33, v37
v_add_f32 v34, v34, v38
v_add_f32 v35, v35, v39
v_add_f32 v40, v40, v44
v_add_f32 v41, v41, v45
v_add_f32 v42, v42, v46
v_add_f32 v43, v43, v47
s_nop 1
v_permlane16_swap_b32 v24, v26
v_permlane16_swap_b32 v25, v27
v_permlane16_swap_b32 v32, v34
v_permlane16_swap_b32 v33, v35
v_permlane16_swap_b32 v40, v42
v_permlane16_swap_b32 v41, v43
s_nop 0
v_add_f32 v24, v24, v26
v_add_f32 v25, v25, v27
v_add_f32 v32, v32, v34
v_add_f32 v33, v33, v35
v_add_f32 v40, v40, v42
v_add_f32 v41, v41, v43
s_nop 1
v_add_f32_dpp v24, v24, v24 row_ror:8 row_mask:0xf bank_mask:0xf
v_add_f32_dpp v25, v25, v25 row_ror:8 row_mask:0xf bank_mask:0xf
v_add_f32_dpp v32, v32, v32 row_ror:8 row_mask:0xf bank_mask:0xf
v_add_f32_dpp v33, v33, v33 row_ror:8 row_mask:0xf bank_mask:0xf
v_add_f32_dpp v40, v40, v40 row_ror:8 row_mask:0xf bank_mask:0xf
v_add_f32_dpp v41, v41, v41 row_ror:8 row_mask:0xf bank_mask:0xf
v_mul_f32 v24, v106, v24
v_mul_f32 v25, v106, v25
ds_write_b64 v105, v[24:25] offset:0
v_mul_f32 v32, v106, v32
v_mul_f32 v33, v106, v33
ds_write_b64 v105, v[32:33] offset:256
v_mul_f32 v40, v106, v40
v_mul_f32 v41, v106, v41
ds_write_b64 v105, v[40:41] offset:512
s_waitcnt lgkmcnt(0)
s_cmp_eq_u32 s19, 64
s_cbranch_scc1 L_cend
v_mov_b32 v96, 151600
v_mov_b32 v97, 1
s_mov_b64 exec, 1
ds_add_u32 v96, v97
s_mov_b64 exec, -1
v_add_u32 v105, 4096, v105
v_add_u32 v107, 4096, v107
v_add_u32 v109, 32, v109
v_add_u32 v110, 32, v110
s_add_u32 s41, s41, 2048
s_branch L_vstep
L_cend:
s_barrier
s_endpgm
.globl final_kernel
.p2align 8
.type final_kernel,@function
final_kernel:
s_cmp_ge_u32 s2, 160
s_cbranch_scc1 L_fend
s_load_dwordx2 s[16:17], s[0:1], 96
s_load_dwordx2 s[20:21], s[0:1], 0
s_load_dwordx4 s[8:11], s[0:1], 72
s_mul_i32 s12, s2, 1639
s_lshr_b32 s12, s12, 16
s_mul_i32 s13, s12, 40
s_sub_u32 s13, s2, s13
v_and_b32 v1, 63, v0
v_lshrrev_b32 v2, 6, v0
v_lshlrev_b32 v7, 4, v0
v_lshlrev_b32 v3, 12, v2
v_lshl_add_u32 v3, v1, 4, v3
v_lshlrev_b32 v4, 3, v0
s_lshl_b32 s36, s2, 14
s_add_u32 s36, s36, 2097152
s_lshl_b32 s38, s2, 12
s_add_u32 s38, s38, 5242880
s_lshl_b32 s15, s12, 11
s_add_u32 s15, s15, 6291456
s_mov_b32 s18, 6299648
s_mov_b32 s19, 0x20000
v_and_b32 v6, 3, v0
v_lshlrev_b32 v5, 3, v6
s_lshl_b32 s28, s2, 5
s_lshl_b32 s29, s13, 5
s_movk_i32 s22, 5120
s_mov_b32 s23, 0x20000
s_movk_i32 s26, 1280
s_mov_b32 s27, 0x20000
s_waitcnt lgkmcnt(0)
buffer_load_dwordx2 v[40:41], v4, s[16:19], s15 offen
buffer_load_dwordx4 v[16:19], v3, s[16:19], s36 offen offset:0
buffer_load_dwordx4 v[20:23], v3, s[16:19], s36 offen offset:1024
buffer_load_dwordx4 v[24:27], v3, s[16:19], s36 offen offset:2048
buffer_load_dwordx4 v[28:31], v3, s[16:19], s36 offen offset:3072
buffer_load_dwordx4 v[8:11], v7, s[16:19], s38 offen
s_mov_b32 s24, s8
s_mov_b32 s25, s9
buffer_load_dwordx2 v[32:33], v5, s[20:23], s28 offen
buffer_load_dwordx2 v[34:35], v5, s[24:27], s29 offen
s_mov_b32 s32, s10
s_mov_b32 s33, s11
s_movk_i32 s34, 5120
s_mov_b32 s35, 0x20000
s_mov_b32 s30, 1069066811
v_and_b32 v44, 60, v1
v_lshlrev_b32 v56, 7, v2
v_lshl_add_u32 v56, v6, 5, v56
v_lshlrev_b32 v36, 5, v6
s_waitcnt vmcnt(7)
v_mov_b32 v42, v40
s_nop 1
v_max_f32_dpp v42, v42, v42 quad_perm:[1,0,3,2] row_mask:0xf bank_mask:0xf
s_nop 1
v_max_f32_dpp v42, v42, v42 quad_perm:[2,3,0,1] row_mask:0xf bank_mask:0xf
s_nop 1
v_max_f32_dpp v42, v42, v42 row_half_mirror row_mask:0xf bank_mask:0xf
v_sub_f32 v40, v40, v42
v_mul_f32 v40, s30, v40
v_exp_f32 v40, v40
s_nop 0
v_mul_f32 v41, v41, v40
v_mov_b32 v42, v41
s_nop 1
v_add_f32_dpp v42, v42, v42 quad_perm:[1,0,3,2] row_mask:0xf bank_mask:0xf
s_nop 1
v_add_f32_dpp v42, v42, v42 quad_perm:[2,3,0,1] row_mask:0xf bank_mask:0xf
s_nop 1
v_add_f32_dpp v42, v42, v42 row_half_mirror row_mask:0xf bank_mask:0xf
v_rcp_f32 v42, v42
s_nop 0
v_mul_f32 v41, v41, v42
ds_bpermute_b32 v48, v44, v41 offset:0
ds_bpermute_b32 v49, v44, v41 offset:64
ds_bpermute_b32 v50, v44, v41 offset:128
ds_bpermute_b32 v51, v44, v41 offset:192
s_waitcnt vmcnt(3) lgkmcnt(0)
v_mul_f32 v12, v48, v16
v_fmac_f32 v12, v49, v20
v_fmac_f32 v12, v50, v24
v_fmac_f32 v12, v51, v28
v_mul_f32 v13, v48, v17
v_fmac_f32 v13, v49, v21
v_fmac_f32 v13, v50, v25
v_fmac_f32 v13, v51, v29
v_mul_f32 v14, v48, v18
v_fmac_f32 v14, v49, v22
v_fmac_f32 v14, v50, v26
v_fmac_f32 v14, v51, v30
v_mul_f32 v15, v48, v19
v_fmac_f32 v15, v49, v23
v_fmac_f32 v15, v50, v27
v_fmac_f32 v15, v51, v31
s_waitcnt vmcnt(2)
s_nop 0
v_permlane32_swap_b32 v8, v12
v_permlane32_swap_b32 v9, v13
v_permlane32_swap_b32 v10, v14
v_permlane32_swap_b32 v11, v15
s_nop 0
v_add_f32 v8, v8, v12
v_add_f32 v9, v9, v13
v_add_f32 v10, v10, v14
v_add_f32 v11, v11, v15
s_nop 0
v_permlane16_swap_b32 v8, v10
v_permlane16_swap_b32 v9, v11
s_nop 0
v_add_f32 v8, v8, v10
v_add_f32 v9, v9, v11
s_nop 0
v_add_f32_dpp v8, v8, v8 row_ror:4 row_mask:0xf bank_mask:0xf
v_add_f32_dpp v9, v9, v9 row_ror:4 row_mask:0xf bank_mask:0xf
s_nop 0
v_add_f32_dpp v8, v8, v8 row_ror:8 row_mask:0xf bank_mask:0xf
v_add_f32_dpp v9, v9, v9 row_ror:8 row_mask:0xf bank_mask:0xf
v_lshrrev_b32 v12, 4, v1
v_lshl_add_u32 v56, v12, 3, v56
ds_write_b64 v56, v[8:9]
s_waitcnt lgkmcnt(0)
s_barrier
v_cmp_gt_u32 vcc, 4, v0
s_and_saveexec_b64 s[44:45], vcc
s_cbranch_execz L_fend
ds_read_b128 v[8:11], v36 offset:0
ds_read_b128 v[12:15], v36 offset:16
ds_read_b128 v[48:51], v36 offset:128
ds_read_b128 v[52:55], v36 offset:144
ds_read_b128 v[56:59], v36 offset:256
ds_read_b128 v[60:63], v36 offset:272
ds_read_b128 v[64:67], v36 offset:384
ds_read_b128 v[68:71], v36 offset:400
s_waitcnt vmcnt(0)
v_lshlrev_b32 v16, 16, v34
v_and_b32 v17, 0xffff0000, v34
v_lshlrev_b32 v18, 16, v35
v_and_b32 v19, 0xffff0000, v35
v_lshlrev_b32 v20, 16, v32
v_and_b32 v21, 0xffff0000, v32
v_lshlrev_b32 v22, 16, v33
v_and_b32 v23, 0xffff0000, v33
s_waitcnt lgkmcnt(0)
v_pk_add_f32 v[8:9], v[8:9], v[48:49]
v_pk_add_f32 v[10:11], v[10:11], v[50:51]
v_pk_add_f32 v[12:13], v[12:13], v[52:53]
v_pk_add_f32 v[14:15], v[14:15], v[54:55]
v_pk_add_f32 v[56:57], v[56:57], v[64:65]
v_pk_add_f32 v[58:59], v[58:59], v[66:67]
v_pk_add_f32 v[60:61], v[60:61], v[68:69]
v_pk_add_f32 v[62:63], v[62:63], v[70:71]
v_pk_add_f32 v[8:9], v[8:9], v[56:57]
v_pk_add_f32 v[10:11], v[10:11], v[58:59]
v_pk_add_f32 v[12:13], v[12:13], v[60:61]
v_pk_add_f32 v[14:15], v[14:15], v[62:63]
v_cvt_pk_bf16_f32 v8, v8, v8
v_and_b32 v8, 0xffff0000, v8
v_cvt_pk_bf16_f32 v9, v9, v9
v_and_b32 v9, 0xffff0000, v9
v_cvt_pk_bf16_f32 v10, v10, v10
v_and_b32 v10, 0xffff0000, v10
v_cvt_pk_bf16_f32 v11, v11, v11
v_and_b32 v11, 0xffff0000, v11
v_cvt_pk_bf16_f32 v12, v12, v12
v_and_b32 v12, 0xffff0000, v12
v_cvt_pk_bf16_f32 v13, v13, v13
v_and_b32 v13, 0xffff0000, v13
v_cvt_pk_bf16_f32 v14, v14, v14
v_and_b32 v14, 0xffff0000, v14
v_cvt_pk_bf16_f32 v15, v15, v15
v_and_b32 v15, 0xffff0000, v15
v_pk_add_f32 v[8:9], v[8:9], v[16:17]
v_pk_add_f32 v[10:11], v[10:11], v[18:19]
v_pk_add_f32 v[12:13], v[12:13], v[20:21]
v_pk_add_f32 v[14:15], v[14:15], v[22:23]
v_cvt_pk_bf16_f32 v8, v8, v8
v_and_b32 v8, 0xffff0000, v8
v_cvt_pk_bf16_f32 v9, v9, v9
v_and_b32 v9, 0xffff0000, v9
v_cvt_pk_bf16_f32 v10, v10, v10
v_and_b32 v10, 0xffff0000, v10
v_cvt_pk_bf16_f32 v11, v11, v11
v_and_b32 v11, 0xffff0000, v11
v_cvt_pk_bf16_f32 v12, v12, v12
v_and_b32 v12, 0xffff0000, v12
v_cvt_pk_bf16_f32 v13, v13, v13
v_and_b32 v13, 0xffff0000, v13
v_cvt_pk_bf16_f32 v14, v14, v14
v_and_b32 v14, 0xffff0000, v14
v_cvt_pk_bf16_f32 v15, v15, v15
v_and_b32 v15, 0xffff0000, v15
v_pk_add_f32 v[8:9], v[8:9], v[12:13]
v_pk_add_f32 v[10:11], v[10:11], v[14:15]
v_cvt_pk_bf16_f32 v16, v8, v9
v_cvt_pk_bf16_f32 v17, v10, v11
buffer_store_dwordx2 v[16:17], v5, s[32:35], s28 offen
L_fend:
s_endpgm
L_pj:
v_mov_b32 v112, 0
v_mov_b32 v113, 0
v_mov_b32 v114, 0
v_mov_b32 v115, 0
v_mov_b32 v116, 0
v_mov_b32 v117, 0
v_mov_b32 v118, 0
v_mov_b32 v119, 0
s_cmp_eq_u32 s40, 4
s_cbranch_scc1 L_pjb
v_mov_b32 v1, 151600
s_lshl_b32 s17, s40, 2
L_polla:
ds_read_b32 v0, v1
s_waitcnt lgkmcnt(0)
v_readfirstlane_b32 s24, v0
s_nop 0
s_cmp_ge_u32 s24, s17
s_cbranch_scc1 L_polloka
s_sleep 32
s_branch L_polla
L_polloka:
s_branch L_pj2
L_pjb:
s_cmp_eq_u32 s46, 0
s_cbranch_scc1 L_x0
ds_write_b64 v12, v[14:15]
ds_write_b64 v12, v[120:121] offset:2560
ds_write_b64 v12, v[122:123] offset:5120
ds_write_b64 v12, v[124:125] offset:7680
s_waitcnt lgkmcnt(0)
v_mov_b32 v1, 151604
v_mov_b32 v0, 1
s_mov_b64 exec, 1
ds_add_u32 v1, v0
s_mov_b64 exec, -1
s_branch L_x1
L_x0:
v_mov_b32 v1, 151604
L_pollxh:
ds_read_b32 v0, v1
s_waitcnt lgkmcnt(0)
v_readfirstlane_b32 s24, v0
s_nop 0
s_cmp_ge_u32 s24, 5
s_cbranch_scc1 L_pollokxh
s_sleep 4
s_branch L_pollxh
L_pollokxh:
ds_read_b64 v[2:3], v12 offset:0
ds_read_b64 v[4:5], v12 offset:2560
ds_read_b64 v[6:7], v12 offset:5120
ds_read_b64 v[8:9], v12 offset:7680
s_waitcnt lgkmcnt(0)
v_pk_add_f32 v[14:15], v[14:15], v[2:3]
v_pk_add_f32 v[120:121], v[120:121], v[4:5]
v_pk_add_f32 v[122:123], v[122:123], v[6:7]
v_pk_add_f32 v[124:125], v[124:125], v[8:9]
v_lshrrev_b32 v2, 14, v11
v_lshlrev_b32 v2, 12, v2
v_and_b32 v3, 63, v11
v_add_u32 v2, v2, v3
v_mov_b32 v1, 151552
L_pollls:
ds_read_b32 v0, v1
s_waitcnt lgkmcnt(0)
v_readfirstlane_b32 s24, v0
s_nop 0
s_cmp_ge_u32 s24, 250
s_cbranch_scc1 L_pollokls
s_sleep 8
s_branch L_pollls
L_pollokls:
buffer_store_dwordx2 v[14:15], v2, s[12:15], s50 offen
buffer_store_dwordx2 v[120:121], v11, s[12:15], s51 offen
buffer_store_dwordx2 v[122:123], v11, s[12:15], s52 offen
buffer_store_dwordx2 v[124:125], v11, s[12:15], s53 offen
L_x1:
s_setprio 2
s_barrier
L_pj2:
ds_read_b64 v[2:3], v10 offset:0
ds_read_b64 v[4:5], v10 offset:1024
ds_read_b64 v[6:7], v10 offset:2048
ds_read_b64 v[8:9], v10 offset:3072
s_waitcnt lgkmcnt(2)
v_pk_add_f32 v[2:3], v[2:3], v[4:5]
s_waitcnt lgkmcnt(0)
v_pk_add_f32 v[6:7], v[6:7], v[8:9]
v_pk_add_f32 v[2:3], v[2:3], v[6:7]
v_cvt_pk_bf16_f32 v2, v2, v3
s_nop 1
v_dot2c_f32_bf16_dpp v112, v2, v16 row_newbcast:0 row_mask:0xf bank_mask:0xf
v_dot2c_f32_bf16_dpp v113, v2, v20 row_newbcast:0 row_mask:0xf bank_mask:0xf
v_dot2c_f32_bf16_dpp v114, v2, v17 row_newbcast:0 row_mask:0xf bank_mask:0xf
v_dot2c_f32_bf16_dpp v115, v2, v21 row_newbcast:0 row_mask:0xf bank_mask:0xf
v_dot2c_f32_bf16_dpp v116, v2, v18 row_newbcast:0 row_mask:0xf bank_mask:0xf
v_dot2c_f32_bf16_dpp v117, v2, v22 row_newbcast:0 row_mask:0xf bank_mask:0xf
v_dot2c_f32_bf16_dpp v118, v2, v19 row_newbcast:0 row_mask:0xf bank_mask:0xf
v_dot2c_f32_bf16_dpp v119, v2, v23 row_newbcast:0 row_mask:0xf bank_mask:0xf
v_dot2c_f32_bf16_dpp v112, v2, v24 row_newbcast:1 row_mask:0xf bank_mask:0xf
v_dot2c_f32_bf16_dpp v113, v2, v28 row_newbcast:1 row_mask:0xf bank_mask:0xf
v_dot2c_f32_bf16_dpp v114, v2, v25 row_newbcast:1 row_mask:0xf bank_mask:0xf
v_dot2c_f32_bf16_dpp v115, v2, v29 row_newbcast:1 row_mask:0xf bank_mask:0xf
v_dot2c_f32_bf16_dpp v116, v2, v26 row_newbcast:1 row_mask:0xf bank_mask:0xf
v_dot2c_f32_bf16_dpp v117, v2, v30 row_newbcast:1 row_mask:0xf bank_mask:0xf
v_dot2c_f32_bf16_dpp v118, v2, v27 row_newbcast:1 row_mask:0xf bank_mask:0xf
v_dot2c_f32_bf16_dpp v119, v2, v31 row_newbcast:1 row_mask:0xf bank_mask:0xf
v_dot2c_f32_bf16_dpp v112, v2, v32 row_newbcast:2 row_mask:0xf bank_mask:0xf
v_dot2c_f32_bf16_dpp v113, v2, v36 row_newbcast:2 row_mask:0xf bank_mask:0xf
v_dot2c_f32_bf16_dpp v114, v2, v33 row_newbcast:2 row_mask:0xf bank_mask:0xf
v_dot2c_f32_bf16_dpp v115, v2, v37 row_newbcast:2 row_mask:0xf bank_mask:0xf
v_dot2c_f32_bf16_dpp v116, v2, v34 row_newbcast:2 row_mask:0xf bank_mask:0xf
v_dot2c_f32_bf16_dpp v117, v2, v38 row_newbcast:2 row_mask:0xf bank_mask:0xf
v_dot2c_f32_bf16_dpp v118, v2, v35 row_newbcast:2 row_mask:0xf bank_mask:0xf
v_dot2c_f32_bf16_dpp v119, v2, v39 row_newbcast:2 row_mask:0xf bank_mask:0xf
v_dot2c_f32_bf16_dpp v112, v2, v40 row_newbcast:3 row_mask:0xf bank_mask:0xf
v_dot2c_f32_bf16_dpp v113, v2, v44 row_newbcast:3 row_mask:0xf bank_mask:0xf
v_dot2c_f32_bf16_dpp v114, v2, v41 row_newbcast:3 row_mask:0xf bank_mask:0xf
v_dot2c_f32_bf16_dpp v115, v2, v45 row_newbcast:3 row_mask:0xf bank_mask:0xf
v_dot2c_f32_bf16_dpp v116, v2, v42 row_newbcast:3 row_mask:0xf bank_mask:0xf
v_dot2c_f32_bf16_dpp v117, v2, v46 row_newbcast:3 row_mask:0xf bank_mask:0xf
v_dot2c_f32_bf16_dpp v118, v2, v43 row_newbcast:3 row_mask:0xf bank_mask:0xf
v_dot2c_f32_bf16_dpp v119, v2, v47 row_newbcast:3 row_mask:0xf bank_mask:0xf
v_dot2c_f32_bf16_dpp v112, v2, v48 row_newbcast:4 row_mask:0xf bank_mask:0xf
v_dot2c_f32_bf16_dpp v113, v2, v52 row_newbcast:4 row_mask:0xf bank_mask:0xf
v_dot2c_f32_bf16_dpp v114, v2, v49 row_newbcast:4 row_mask:0xf bank_mask:0xf
v_dot2c_f32_bf16_dpp v115, v2, v53 row_newbcast:4 row_mask:0xf bank_mask:0xf
v_dot2c_f32_bf16_dpp v116, v2, v50 row_newbcast:4 row_mask:0xf bank_mask:0xf
v_dot2c_f32_bf16_dpp v117, v2, v54 row_newbcast:4 row_mask:0xf bank_mask:0xf
v_dot2c_f32_bf16_dpp v118, v2, v51 row_newbcast:4 row_mask:0xf bank_mask:0xf
v_dot2c_f32_bf16_dpp v119, v2, v55 row_newbcast:4 row_mask:0xf bank_mask:0xf
v_dot2c_f32_bf16_dpp v112, v2, v56 row_newbcast:5 row_mask:0xf bank_mask:0xf
v_dot2c_f32_bf16_dpp v113, v2, v60 row_newbcast:5 row_mask:0xf bank_mask:0xf
v_dot2c_f32_bf16_dpp v114, v2, v57 row_newbcast:5 row_mask:0xf bank_mask:0xf
v_dot2c_f32_bf16_dpp v115, v2, v61 row_newbcast:5 row_mask:0xf bank_mask:0xf
v_dot2c_f32_bf16_dpp v116, v2, v58 row_newbcast:5 row_mask:0xf bank_mask:0xf
v_dot2c_f32_bf16_dpp v117, v2, v62 row_newbcast:5 row_mask:0xf bank_mask:0xf
v_dot2c_f32_bf16_dpp v118, v2, v59 row_newbcast:5 row_mask:0xf bank_mask:0xf
v_dot2c_f32_bf16_dpp v119, v2, v63 row_newbcast:5 row_mask:0xf bank_mask:0xf
v_dot2c_f32_bf16_dpp v112, v2, v64 row_newbcast:6 row_mask:0xf bank_mask:0xf
v_dot2c_f32_bf16_dpp v113, v2, v68 row_newbcast:6 row_mask:0xf bank_mask:0xf
v_dot2c_f32_bf16_dpp v114, v2, v65 row_newbcast:6 row_mask:0xf bank_mask:0xf
v_dot2c_f32_bf16_dpp v115, v2, v69 row_newbcast:6 row_mask:0xf bank_mask:0xf
v_dot2c_f32_bf16_dpp v116, v2, v66 row_newbcast:6 row_mask:0xf bank_mask:0xf
v_dot2c_f32_bf16_dpp v117, v2, v70 row_newbcast:6 row_mask:0xf bank_mask:0xf
v_dot2c_f32_bf16_dpp v118, v2, v67 row_newbcast:6 row_mask:0xf bank_mask:0xf
v_dot2c_f32_bf16_dpp v119, v2, v71 row_newbcast:6 row_mask:0xf bank_mask:0xf
v_dot2c_f32_bf16_dpp v112, v2, v72 row_newbcast:7 row_mask:0xf bank_mask:0xf
v_dot2c_f32_bf16_dpp v113, v2, v76 row_newbcast:7 row_mask:0xf bank_mask:0xf
v_dot2c_f32_bf16_dpp v114, v2, v73 row_newbcast:7 row_mask:0xf bank_mask:0xf
v_dot2c_f32_bf16_dpp v115, v2, v77 row_newbcast:7 row_mask:0xf bank_mask:0xf
v_dot2c_f32_bf16_dpp v116, v2, v74 row_newbcast:7 row_mask:0xf bank_mask:0xf
v_dot2c_f32_bf16_dpp v117, v2, v78 row_newbcast:7 row_mask:0xf bank_mask:0xf
v_dot2c_f32_bf16_dpp v118, v2, v75 row_newbcast:7 row_mask:0xf bank_mask:0xf
v_dot2c_f32_bf16_dpp v119, v2, v79 row_newbcast:7 row_mask:0xf bank_mask:0xf
v_dot2c_f32_bf16_dpp v112, v2, v80 row_newbcast:8 row_mask:0xf bank_mask:0xf
v_dot2c_f32_bf16_dpp v113, v2, v84 row_newbcast:8 row_mask:0xf bank_mask:0xf
v_dot2c_f32_bf16_dpp v114, v2, v81 row_newbcast:8 row_mask:0xf bank_mask:0xf
v_dot2c_f32_bf16_dpp v115, v2, v85 row_newbcast:8 row_mask:0xf bank_mask:0xf
v_dot2c_f32_bf16_dpp v116, v2, v82 row_newbcast:8 row_mask:0xf bank_mask:0xf
v_dot2c_f32_bf16_dpp v117, v2, v86 row_newbcast:8 row_mask:0xf bank_mask:0xf
v_dot2c_f32_bf16_dpp v118, v2, v83 row_newbcast:8 row_mask:0xf bank_mask:0xf
v_dot2c_f32_bf16_dpp v119, v2, v87 row_newbcast:8 row_mask:0xf bank_mask:0xf
v_dot2c_f32_bf16_dpp v112, v2, v88 row_newbcast:9 row_mask:0xf bank_mask:0xf
v_dot2c_f32_bf16_dpp v113, v2, v92 row_newbcast:9 row_mask:0xf bank_mask:0xf
v_dot2c_f32_bf16_dpp v114, v2, v89 row_newbcast:9 row_mask:0xf bank_mask:0xf
v_dot2c_f32_bf16_dpp v115, v2, v93 row_newbcast:9 row_mask:0xf bank_mask:0xf
v_dot2c_f32_bf16_dpp v116, v2, v90 row_newbcast:9 row_mask:0xf bank_mask:0xf
v_dot2c_f32_bf16_dpp v117, v2, v94 row_newbcast:9 row_mask:0xf bank_mask:0xf
v_dot2c_f32_bf16_dpp v118, v2, v91 row_newbcast:9 row_mask:0xf bank_mask:0xf
v_dot2c_f32_bf16_dpp v119, v2, v95 row_newbcast:9 row_mask:0xf bank_mask:0xf
v_dot2c_f32_bf16_dpp v112, v2, v96 row_newbcast:10 row_mask:0xf bank_mask:0xf
v_dot2c_f32_bf16_dpp v113, v2, v100 row_newbcast:10 row_mask:0xf bank_mask:0xf
v_dot2c_f32_bf16_dpp v114, v2, v97 row_newbcast:10 row_mask:0xf bank_mask:0xf
v_dot2c_f32_bf16_dpp v115, v2, v101 row_newbcast:10 row_mask:0xf bank_mask:0xf
v_dot2c_f32_bf16_dpp v116, v2, v98 row_newbcast:10 row_mask:0xf bank_mask:0xf
v_dot2c_f32_bf16_dpp v117, v2, v102 row_newbcast:10 row_mask:0xf bank_mask:0xf
v_dot2c_f32_bf16_dpp v118, v2, v99 row_newbcast:10 row_mask:0xf bank_mask:0xf
v_dot2c_f32_bf16_dpp v119, v2, v103 row_newbcast:10 row_mask:0xf bank_mask:0xf
v_dot2c_f32_bf16_dpp v112, v2, v104 row_newbcast:11 row_mask:0xf bank_mask:0xf
v_dot2c_f32_bf16_dpp v113, v2, v108 row_newbcast:11 row_mask:0xf bank_mask:0xf
v_dot2c_f32_bf16_dpp v114, v2, v105 row_newbcast:11 row_mask:0xf bank_mask:0xf
v_dot2c_f32_bf16_dpp v115, v2, v109 row_newbcast:11 row_mask:0xf bank_mask:0xf
v_dot2c_f32_bf16_dpp v116, v2, v106 row_newbcast:11 row_mask:0xf bank_mask:0xf
v_dot2c_f32_bf16_dpp v117, v2, v110 row_newbcast:11 row_mask:0xf bank_mask:0xf
v_dot2c_f32_bf16_dpp v118, v2, v107 row_newbcast:11 row_mask:0xf bank_mask:0xf
v_dot2c_f32_bf16_dpp v119, v2, v111 row_newbcast:11 row_mask:0xf bank_mask:0xf
s_nop 2
v_permlane32_swap_b32 v112, v116
v_permlane32_swap_b32 v113, v117
v_permlane32_swap_b32 v114, v118
v_permlane32_swap_b32 v115, v119
s_nop 0
v_add_f32 v112, v112, v116
v_add_f32 v113, v113, v117
v_add_f32 v114, v114, v118
v_add_f32 v115, v115, v119
s_nop 0
v_permlane16_swap_b32 v112, v114
v_permlane16_swap_b32 v113, v115
s_nop 0
v_add_f32 v112, v112, v114
v_add_f32 v113, v113, v115
s_cmp_eq_u32 s40, 4
s_cbranch_scc1 L_plast
v_mov_b32 v120, v122
v_mov_b32 v121, v123
v_mov_b32 v122, v124
v_mov_b32 v123, v125
v_mov_b32 v124, v112
v_mov_b32 v125, v113
v_add_u32 v10, 4096, v10
s_add_u32 s40, s40, 1
s_branch L_pj
L_plast:
s_cmp_eq_u32 s46, 0
s_cbranch_scc1 L_p0
ds_write_b64 v12, v[112:113]
s_waitcnt lgkmcnt(0)
s_barrier
s_endpgm
L_p0:
s_barrier
ds_read_b64 v[114:115], v12
s_waitcnt lgkmcnt(0)
v_pk_add_f32 v[112:113], v[112:113], v[114:115]
buffer_store_dwordx2 v[112:113], v11, s[12:15], s54 offen
L_end:
s_endpgm
L_prest:
s_lshr_b32 s48, s58, 1
s_and_b32 s6, s58, 1
s_cmp_ge_u32 s18, 5
s_cselect_b32 s46, 1, 0
s_mul_i32 s16, s46, 5
s_sub_u32 s47, s18, s16
s_lshl_b32 s16, s47, 8
v_lshlrev_b32 v4, 4, v2
v_add_u32 v4, s16, v4
v_mul_u32_u24 v5, 5120, v3
v_add_u32 v5, v5, v4
v_mul_u32_u24 v13, 30720, v3
v_add_u32 v13, v13, v4
v_lshlrev_b32 v12, 1, v4
v_lshl_add_u32 v12, v3, 3, v12
v_lshrrev_b32 v11, 6, v12
v_lshlrev_b32 v11, 14, v11
v_and_b32 v7, 63, v12
v_add_u32 v11, v11, v7
v_add_u32 v12, 139264, v12
s_mul_i32 s16, s5, 48
s_mul_i32 s17, s6, 24
s_add_u32 s16, s16, s17
s_mul_i32 s20, s46, 12
s_add_u32 s16, s16, s20
s_mul_i32 s16, s16, 1280
s_add_u32 s8, s80, s16
s_addc_u32 s9, s81, 0
s_movk_i32 s10, 15360
s_add_u32 s17, s17, s20
s_lshl_b32 s17, s17, 1
s_add_u32 s16, s17, 149888
v_min_u32 v6, 2, v3
v_lshlrev_b32 v6, 3, v6
v_and_b32 v7, 1, v2
v_lshl_add_u32 v6, v7, 2, v6
v_add_u32 v6, s16, v6
v_min_u32 v10, 11, v2
v_mul_u32_u24 v7, 12, v3
v_add_u32 v10, v10, v7
v_lshlrev_b32 v10, 3, v10
s_mul_i32 s16, s46, 384
s_add_u32 s16, s16, 122880
v_add_u32 v10, s16, v10
s_mul_i32 s16, s5, 192
s_mul_i32 s17, s46, 96
s_add_u32 s16, s16, s17
s_mul_i32 s17, s16, 1280
s_add_u32 s36, s72, s17
s_addc_u32 s37, s73, 0
s_mov_b32 s38, 122880
s_mov_b32 s39, 0x20000
s_mov_b32 s12, s88
s_mov_b32 s13, s89
s_mov_b32 s14, 5898240
s_mov_b32 s15, 0x20000
s_mul_i32 s16, s48, 163840
s_lshl_b32 s17, s5, 1
s_add_u32 s17, s17, s6
s_lshl_b32 s17, s17, 6
s_add_u32 s16, s16, s17
s_add_u32 s50, s16, 5242880
s_lshl_b32 s16, s5, 3
s_add_u32 s16, s16, s58
s_lshl_b32 s16, s16, 6
s_add_u32 s51, s16, 2097152
s_add_u32 s52, s16, 2752512
s_add_u32 s53, s16, 3407872
s_add_u32 s54, s16, 4063232
v_mov_b32 v1, 151592
L_pollh:
ds_read_b32 v0, v1
s_waitcnt lgkmcnt(0)
v_readfirstlane_b32 s24, v0
s_nop 0
s_cmp_ge_u32 s24, 5
s_cbranch_scc1 L_pollokh
s_sleep 8
s_branch L_pollh
L_pollokh:
buffer_load_dwordx4 v[16:19], v5, s[8:11], 0 offen offset:0 nt
buffer_load_dwordx4 v[20:23], v5, s[8:11], 0 offen offset:1280 nt
buffer_load_dwordx4 v[24:27], v5, s[8:11], 0 offen offset:2560 nt
buffer_load_dwordx4 v[28:31], v5, s[8:11], 0 offen offset:3840 nt
ds_read_b32 v3, v6
v_mov_b32 v112, 0
v_mov_b32 v113, 0
v_mov_b32 v114, 0
v_mov_b32 v115, 0
v_mov_b32 v116, 0
v_mov_b32 v117, 0
v_mov_b32 v118, 0
v_mov_b32 v119, 0
s_waitcnt vmcnt(0) lgkmcnt(0)
v_perm_b32 v2, v20, v16, s44
v_perm_b32 v20, v20, v16, s45
v_mov_b32 v16, v2
v_perm_b32 v2, v21, v17, s44
v_perm_b32 v21, v21, v17, s45
v_mov_b32 v17, v2
v_perm_b32 v2, v22, v18, s44
v_perm_b32 v22, v22, v18, s45
v_mov_b32 v18, v2
v_perm_b32 v2, v23, v19, s44
v_perm_b32 v23, v23, v19, s45
v_mov_b32 v19, v2
v_perm_b32 v2, v28, v24, s44
v_perm_b32 v28, v28, v24, s45
v_mov_b32 v24, v2
v_perm_b32 v2, v29, v25, s44
v_perm_b32 v29, v29, v25, s45
v_mov_b32 v25, v2
v_perm_b32 v2, v30, v26, s44
v_perm_b32 v30, v30, v26, s45
v_mov_b32 v26, v2
v_perm_b32 v2, v31, v27, s44
v_perm_b32 v31, v31, v27, s45
v_mov_b32 v27, v2
v_dot2c_f32_bf16_dpp v112, v3, v16 row_newbcast:0 row_mask:0xf bank_mask:0xf
v_dot2c_f32_bf16_dpp v113, v3, v20 row_newbcast:0 row_mask:0xf bank_mask:0xf
v_dot2c_f32_bf16_dpp v114, v3, v17 row_newbcast:0 row_mask:0xf bank_mask:0xf
v_dot2c_f32_bf16_dpp v115, v3, v21 row_newbcast:0 row_mask:0xf bank_mask:0xf
v_dot2c_f32_bf16_dpp v116, v3, v18 row_newbcast:0 row_mask:0xf bank_mask:0xf
v_dot2c_f32_bf16_dpp v117, v3, v22 row_newbcast:0 row_mask:0xf bank_mask:0xf
v_dot2c_f32_bf16_dpp v118, v3, v19 row_newbcast:0 row_mask:0xf bank_mask:0xf
v_dot2c_f32_bf16_dpp v119, v3, v23 row_newbcast:0 row_mask:0xf bank_mask:0xf
v_dot2c_f32_bf16_dpp v112, v3, v24 row_newbcast:1 row_mask:0xf bank_mask:0xf
v_dot2c_f32_bf16_dpp v113, v3, v28 row_newbcast:1 row_mask:0xf bank_mask:0xf
v_dot2c_f32_bf16_dpp v114, v3, v25 row_newbcast:1 row_mask:0xf bank_mask:0xf
v_dot2c_f32_bf16_dpp v115, v3, v29 row_newbcast:1 row_mask:0xf bank_mask:0xf
v_dot2c_f32_bf16_dpp v116, v3, v26 row_newbcast:1 row_mask:0xf bank_mask:0xf
v_dot2c_f32_bf16_dpp v117, v3, v30 row_newbcast:1 row_mask:0xf bank_mask:0xf
v_dot2c_f32_bf16_dpp v118, v3, v27 row_newbcast:1 row_mask:0xf bank_mask:0xf
v_dot2c_f32_bf16_dpp v119, v3, v31 row_newbcast:1 row_mask:0xf bank_mask:0xf
s_nop 2
v_permlane32_swap_b32 v112, v116
v_permlane32_swap_b32 v113, v117
v_permlane32_swap_b32 v114, v118
v_permlane32_swap_b32 v115, v119
s_nop 0
v_add_f32 v112, v112, v116
v_add_f32 v113, v113, v117
v_add_f32 v114, v114, v118
v_add_f32 v115, v115, v119
s_nop 0
v_permlane16_swap_b32 v112, v114
v_permlane16_swap_b32 v113, v115
s_nop 0
v_add_f32 v112, v112, v114
v_add_f32 v113, v113, v115
v_mov_b32 v14, v112
v_mov_b32 v15, v113
v_mov_b32 v1, 151552
L_polllwo0:
ds_read_b32 v0, v1
s_waitcnt lgkmcnt(0)
v_readfirstlane_b32 s24, v0
s_nop 0
s_cmp_ge_u32 s24, 22
s_cbranch_scc1 L_polloklwo0
s_sleep 16
s_branch L_polllwo0
L_polloklwo0:
L_polllwo:
ds_read_b32 v0, v1
s_waitcnt lgkmcnt(0)
v_readfirstlane_b32 s24, v0
s_nop 0
s_cmp_ge_u32 s24, 24
s_cbranch_scc1 L_polloklwo
s_sleep 1
s_branch L_polllwo
L_polloklwo:
s_movk_i32 s20, 0
buffer_load_dwordx4 v[16:19], v13, s[36:39], s20 offen offset:0 nt
buffer_load_dwordx4 v[20:23], v13, s[36:39], s20 offen offset:1280 nt
s_waitcnt vmcnt(1)
buffer_load_dwordx4 v[24:27], v13, s[36:39], s20 offen offset:2560 nt
s_waitcnt vmcnt(1)
v_perm_b32 v2, v20, v16, s44
v_perm_b32 v20, v20, v16, s45
v_mov_b32 v16, v2
v_perm_b32 v2, v21, v17, s44
v_perm_b32 v21, v21, v17, s45
v_mov_b32 v17, v2
v_perm_b32 v2, v22, v18, s44
v_perm_b32 v22, v22, v18, s45
v_mov_b32 v18, v2
v_perm_b32 v2, v23, v19, s44
v_perm_b32 v23, v23, v19, s45
v_mov_b32 v19, v2
s_movk_i32 s20, 3840
buffer_load_dwordx4 v[28:31], v13, s[36:39], s20 offen offset:0 nt
s_waitcnt vmcnt(1)
buffer_load_dwordx4 v[32:35], v13, s[36:39], s20 offen offset:1280 nt
s_waitcnt vmcnt(1)
v_perm_b32 v2, v28, v24, s44
v_perm_b32 v28, v28, v24, s45
v_mov_b32 v24, v2
v_perm_b32 v2, v29, v25, s44
v_perm_b32 v29, v29, v25, s45
v_mov_b32 v25, v2
v_perm_b32 v2, v30, v26, s44
v_perm_b32 v30, v30, v26, s45
v_mov_b32 v26, v2
v_perm_b32 v2, v31, v27, s44
v_perm_b32 v31, v31, v27, s45
v_mov_b32 v27, v2
buffer_load_dwordx4 v[36:39], v13, s[36:39], s20 offen offset:2560 nt
s_waitcnt vmcnt(1)
s_movk_i32 s20, 7680
buffer_load_dwordx4 v[40:43], v13, s[36:39], s20 offen offset:0 nt
s_waitcnt vmcnt(1)
v_perm_b32 v2, v36, v32, s44
v_perm_b32 v36, v36, v32, s45
v_mov_b32 v32, v2
v_perm_b32 v2, v37, v33, s44
v_perm_b32 v37, v37, v33, s45
v_mov_b32 v33, v2
v_perm_b32 v2, v38, v34, s44
v_perm_b32 v38, v38, v34, s45
v_mov_b32 v34, v2
v_perm_b32 v2, v39, v35, s44
v_perm_b32 v39, v39, v35, s45
v_mov_b32 v35, v2
buffer_load_dwordx4 v[44:47], v13, s[36:39], s20 offen offset:1280 nt
s_waitcnt vmcnt(1)
buffer_load_dwordx4 v[48:51], v13, s[36:39], s20 offen offset:2560 nt
s_waitcnt vmcnt(1)
v_perm_b32 v2, v44, v40, s44
v_perm_b32 v44, v44, v40, s45
v_mov_b32 v40, v2
v_perm_b32 v2, v45, v41, s44
v_perm_b32 v45, v45, v41, s45
v_mov_b32 v41, v2
v_perm_b32 v2, v46, v42, s44
v_perm_b32 v46, v46, v42, s45
v_mov_b32 v42, v2
v_perm_b32 v2, v47, v43, s44
v_perm_b32 v47, v47, v43, s45
v_mov_b32 v43, v2
s_movk_i32 s20, 11520
buffer_load_dwordx4 v[52:55], v13, s[36:39], s20 offen offset:0 nt
s_waitcnt vmcnt(1)
buffer_load_dwordx4 v[56:59], v13, s[36:39], s20 offen offset:1280 nt
s_waitcnt vmcnt(1)
v_perm_b32 v2, v52, v48, s44
v_perm_b32 v52, v52, v48, s45
v_mov_b32 v48, v2
v_perm_b32 v2, v53, v49, s44
v_perm_b32 v53, v53, v49, s45
v_mov_b32 v49, v2
v_perm_b32 v2, v54, v50, s44
v_perm_b32 v54, v54, v50, s45
v_mov_b32 v50, v2
v_perm_b32 v2, v55, v51, s44
v_perm_b32 v55, v55, v51, s45
v_mov_b32 v51, v2
buffer_load_dwordx4 v[60:63], v13, s[36:39], s20 offen offset:2560 nt
s_waitcnt vmcnt(1)
s_movk_i32 s20, 15360
buffer_load_dwordx4 v[64:67], v13, s[36:39], s20 offen offset:0 nt
s_waitcnt vmcnt(1)
v_perm_b32 v2, v60, v56, s44
v_perm_b32 v60, v60, v56, s45
v_mov_b32 v56, v2
v_perm_b32 v2, v61, v57, s44
v_perm_b32 v61, v61, v57, s45
v_mov_b32 v57, v2
v_perm_b32 v2, v62, v58, s44
v_perm_b32 v62, v62, v58, s45
v_mov_b32 v58, v2
v_perm_b32 v2, v63, v59, s44
v_perm_b32 v63, v63, v59, s45
v_mov_b32 v59, v2
buffer_load_dwordx4 v[68:71], v13, s[36:39], s20 offen offset:1280 nt
s_waitcnt vmcnt(1)
buffer_load_dwordx4 v[72:75], v13, s[36:39], s20 offen offset:2560 nt
s_waitcnt vmcnt(1)
v_perm_b32 v2, v68, v64, s44
v_perm_b32 v68, v68, v64, s45
v_mov_b32 v64, v2
v_perm_b32 v2, v69, v65, s44
v_perm_b32 v69, v69, v65, s45
v_mov_b32 v65, v2
v_perm_b32 v2, v70, v66, s44
v_perm_b32 v70, v70, v66, s45
v_mov_b32 v66, v2
v_perm_b32 v2, v71, v67, s44
v_perm_b32 v71, v71, v67, s45
v_mov_b32 v67, v2
s_movk_i32 s20, 19200
buffer_load_dwordx4 v[76:79], v13, s[36:39], s20 offen offset:0 nt
s_waitcnt vmcnt(1)
buffer_load_dwordx4 v[80:83], v13, s[36:39], s20 offen offset:1280 nt
s_waitcnt vmcnt(1)
v_perm_b32 v2, v76, v72, s44
v_perm_b32 v76, v76, v72, s45
v_mov_b32 v72, v2
v_perm_b32 v2, v77, v73, s44
v_perm_b32 v77, v77, v73, s45
v_mov_b32 v73, v2
v_perm_b32 v2, v78, v74, s44
v_perm_b32 v78, v78, v74, s45
v_mov_b32 v74, v2
v_perm_b32 v2, v79, v75, s44
v_perm_b32 v79, v79, v75, s45
v_mov_b32 v75, v2
buffer_load_dwordx4 v[84:87], v13, s[36:39], s20 offen offset:2560 nt
s_waitcnt vmcnt(1)
s_movk_i32 s20, 23040
buffer_load_dwordx4 v[88:91], v13, s[36:39], s20 offen offset:0 nt
s_waitcnt vmcnt(1)
v_perm_b32 v2, v84, v80, s44
v_perm_b32 v84, v84, v80, s45
v_mov_b32 v80, v2
v_perm_b32 v2, v85, v81, s44
v_perm_b32 v85, v85, v81, s45
v_mov_b32 v81, v2
v_perm_b32 v2, v86, v82, s44
v_perm_b32 v86, v86, v82, s45
v_mov_b32 v82, v2
v_perm_b32 v2, v87, v83, s44
v_perm_b32 v87, v87, v83, s45
v_mov_b32 v83, v2
buffer_load_dwordx4 v[92:95], v13, s[36:39], s20 offen offset:1280 nt
s_waitcnt vmcnt(1)
buffer_load_dwordx4 v[96:99], v13, s[36:39], s20 offen offset:2560 nt
s_waitcnt vmcnt(1)
v_perm_b32 v2, v92, v88, s44
v_perm_b32 v92, v92, v88, s45
v_mov_b32 v88, v2
v_perm_b32 v2, v93, v89, s44
v_perm_b32 v93, v93, v89, s45
v_mov_b32 v89, v2
v_perm_b32 v2, v94, v90, s44
v_perm_b32 v94, v94, v90, s45
v_mov_b32 v90, v2
v_perm_b32 v2, v95, v91, s44
v_perm_b32 v95, v95, v91, s45
v_mov_b32 v91, v2
s_movk_i32 s20, 26880
buffer_load_dwordx4 v[100:103], v13, s[36:39], s20 offen offset:0 nt
s_waitcnt vmcnt(1)
buffer_load_dwordx4 v[104:107], v13, s[36:39], s20 offen offset:1280 nt
s_waitcnt vmcnt(1)
v_perm_b32 v2, v100, v96, s44
v_perm_b32 v100, v100, v96, s45
v_mov_b32 v96, v2
v_perm_b32 v2, v101, v97, s44
v_perm_b32 v101, v101, v97, s45
v_mov_b32 v97, v2
v_perm_b32 v2, v102, v98, s44
v_perm_b32 v102, v102, v98, s45
v_mov_b32 v98, v2
v_perm_b32 v2, v103, v99, s44
v_perm_b32 v103, v103, v99, s45
v_mov_b32 v99, v2
buffer_load_dwordx4 v[108:111], v13, s[36:39], s20 offen offset:2560 nt
s_waitcnt vmcnt(1)
s_waitcnt vmcnt(0)
v_mov_b32 v1, 151608
v_mov_b32 v0, 1
s_mov_b64 exec, 1
ds_add_u32 v1, v0
s_mov_b64 exec, -1
v_perm_b32 v2, v108, v104, s44
v_perm_b32 v108, v108, v104, s45
v_mov_b32 v104, v2
v_perm_b32 v2, v109, v105, s44
v_perm_b32 v109, v109, v105, s45
v_mov_b32 v105, v2
v_perm_b32 v2, v110, v106, s44
v_perm_b32 v110, v110, v106, s45
v_mov_b32 v106, v2
v_perm_b32 v2, v111, v107, s44
v_perm_b32 v111, v111, v107, s45
v_mov_b32 v107, v2
s_mov_b32 s40, 1
s_branch L_pj
.section .rodata,"a"
.p2align 6
.amdhsa_kernel parallel_sum__gqa_block_cached__dense_activation_squared_relu__decode_kernel
  .amdhsa_next_free_vgpr 128
  .amdhsa_next_free_sgpr 96
  .amdhsa_accum_offset 128
  .amdhsa_group_segment_fixed_size 0
  .amdhsa_kernarg_size 104
  .amdhsa_user_sgpr_count 2
  .amdhsa_user_sgpr_kernarg_segment_ptr 1
  .amdhsa_system_sgpr_workgroup_id_x 1
.end_amdhsa_kernel
.p2align 6
.amdhsa_kernel final_kernel
  .amdhsa_next_free_vgpr 72
  .amdhsa_next_free_sgpr 96
  .amdhsa_accum_offset 72
  .amdhsa_group_segment_fixed_size 0
  .amdhsa_kernarg_size 104
  .amdhsa_user_sgpr_count 2
  .amdhsa_user_sgpr_kernarg_segment_ptr 1
  .amdhsa_system_sgpr_workgroup_id_x 1
.end_amdhsa_kernel
```
